```python
import torch

def _softmax(x, axis=-1):
    return torch.softmax(x, dim=axis)
def _gelu(x):
    return torch.nn.functional.gelu(x, approximate="tanh")
def _silu(x):
    return torch.nn.functional.silu(x)
def _sigmoid(x):
    return torch.sigmoid(x)
def _layernorm(x, axis=-1, eps=1e-5):
    m = x.mean(dim=axis, keepdim=True)
    v = x.var(dim=axis, keepdim=True, unbiased=False)
    return (x - m) / torch.sqrt(v + eps)
def _scatter_add(tgt, idx, src, axis=0):
    return tgt.clone().index_add_(axis, idx, src)
def _segment_sum(src, seg, n):
    out = torch.zeros((n,) + src.shape[1:], dtype=src.dtype)
    return out.index_add_(0, seg, src)
def _pad(x, pw):
    flat = tuple(v for pair in reversed(pw) for v in pair)
    return torch.nn.functional.pad(x, flat)

kernel_name = 'gated_mix__grouped_kv_mqa__moe_arch_mod__prompt'

def setup_inputs():

    _w = (lambda a: (lambda t: t.to(torch.bfloat16) if t.is_floating_point() else t)(torch.as_tensor(a)))
    def _A_setup():
        B, S, D, H = 1, 2048, 512, 32
        Dh = D // H
        return {
            "x": _w((lambda *s: torch.randn(*s, dtype=torch.bfloat16) * 0.05)(B, S, D)),
            "wq": _w((lambda *s: torch.randn(*s, dtype=torch.bfloat16) * 1.6)(D, H * Dh)),
            "wk": _w((lambda *s: torch.randn(*s, dtype=torch.bfloat16) * 1.6)(D, Dh)),
            "wv": _w((lambda *s: torch.randn(*s, dtype=torch.bfloat16) * 0.1)(D, Dh)),
            "wo": _w((lambda *s: torch.randn(*s, dtype=torch.bfloat16) * 0.1)(H * Dh, D)),
        }
    _A_in = _A_setup()

    def _B_setup():
        B, S, D, F, C = 1, 2048, 512, 1792, 1
        return {
            "x": _w((lambda *s: torch.randn(*s, dtype=torch.bfloat16) * 0.05)(B, S, D)),
            "w_r": _w((lambda *s: torch.randn(*s, dtype=torch.bfloat16) * 3.2)(D)),
            "w_gate": _w((lambda *s: torch.randn(*s, dtype=torch.bfloat16) * 0.2)(D, F)),
            "w_up": _w((lambda *s: torch.randn(*s, dtype=torch.bfloat16) * 0.2)(D, F)),
            "w_down": _w((lambda *s: torch.randn(*s, dtype=torch.bfloat16) * 0.2)(F, D)),
        }
    _B_in = _B_setup()

    return {
        "A_x": _A_in["x"],
        "A_wq": _A_in["wq"],
        "A_wk": _A_in["wk"],
        "A_wv": _A_in["wv"],
        "A_wo": _A_in["wo"],
        "B_x": _B_in["x"],
        "B_w_r": _B_in["w_r"],
        "B_w_gate": _B_in["w_gate"],
        "B_w_up": _B_in["w_up"],
        "B_w_down": _B_in["w_down"],
        "gate_w": _w((lambda *s: torch.randn(*s, dtype=torch.bfloat16) * 0.05)(512) * 16.0),
    }

def reference(A_x, A_wq, A_wk, A_wv, A_wo, B_x, B_w_r, B_w_gate, B_w_up, B_w_down, gate_w):
    def _A_ref(x, wq, wk, wv, wo):
        B, S, D = x.shape
        H = 32
        Dh = D // H
        q = (lambda x, *d: x.permute(*d))((x @ wq).reshape(B, S, H, Dh), 0, 2, 1, 3)
        k = x @ wk
        v = x @ wv
        scores = torch.einsum("bhqd,bkd->bhqk", q, k) * (Dh ** -0.5)
        p = _softmax(scores, axis=-1)
        o = torch.einsum("bhqk,bkd->bhqd", p, v)
        return (lambda x, *d: x.permute(*d))(o, 0, 2, 1, 3).reshape(B, S, H * Dh) @ wo

    def _B_ref(x, w_r, w_gate, w_up, w_down):
        B, S, D = x.shape
        C = 1
        r = x @ w_r
        idx = torch.argsort(-r, axis=-1)[:, :C]
        idx_e = (lambda x, n, axis: torch.repeat_interleave(x, n, dim=axis))(idx.reshape(B, C, 1), D, axis=2)
        x_sel = (lambda x, i, axis: torch.take_along_dim(x, i, dim=axis))(x, idx_e, axis=1)
        g = _silu(x_sel @ w_gate)
        u = x_sel @ w_up
        y = (g * u) @ w_down
        r_sel = _sigmoid((lambda x, i, axis: torch.take_along_dim(x, i, dim=axis))(r, idx, axis=1))
        y = y * r_sel.reshape(B, C, 1)
        b_off = (torch.arange(B) * S).reshape(B, 1)
        flat_idx = (idx + b_off).reshape(B * C)
        zero = (x * 0.0).reshape(B * S, D)
        upd = _scatter_add(zero, flat_idx, y.reshape(B * C, D), axis=0)
        return x + upd.reshape(B, S, D)

    x = A_x
    g = _sigmoid((x * gate_w).sum(-1, keepdims=True))
    a = _A_ref(x, A_wq, A_wk, A_wv, A_wo)
    b = _B_ref(x, B_w_r, B_w_gate, B_w_up, B_w_down)
    return g * a + (1 - g) * b
```

```asm
; @launch kernel=prep_kernel grid=(256,1,1) block=(512,1,1) lds=147456
; @launch kernel=attn_kernel grid=(256,1,1) block=(512,1,1) lds=155264
.amdgcn_target "amdgcn-amd-amdhsa--gfx950"
.text
.globl prep_kernel
.p2align 8
.type prep_kernel,@function
prep_kernel:
    s_cmp_ge_u32 s2, 256
    s_cbranch_scc1 K1_exit
    s_load_dwordx16 s[8:23], s[0:1], 0
    s_load_dwordx8 s[28:35], s[0:1], 80
    v_lshrrev_b32 v1, 6, v0
    v_and_b32 v0, 63, v0
    v_readfirstlane_b32 s40, v1
    s_bfe_u32 s43, s2, 0x30003
    s_and_b32 s41, s2, 7
    s_lshr_b32 s42, s2, 6
    s_lshl2_add_u32 s42, s41, s42
    v_and_b32 v3, 15, v0
    v_lshrrev_b32 v2, 4, v0
    v_and_b32 v7, 7, v0
    s_and_b32 s44, s40, 3
    s_cmp_lt_u32 s40, 4
    s_cbranch_scc1 K1_producer
    s_cmp_eq_u32 s43, 7
    s_cbranch_scc0 K1_main
    s_getpc_b64 s[56:57]
K1_pc:
    s_lshl_b32 s53, s44, 13
    v_lshl_add_u32 v140, v0, 7, s53
    v_min_u32 v140, K2_unsafe - K1_pc, v140
    v_mov_b32 v141, s57
    v_add_co_u32 v140, vcc, s56, v140
    s_nop 1
    v_addc_co_u32 v141, vcc, 0, v141, vcc
    global_load_dword v143, v[140:141], off
    s_branch K1_main
K1_producer:
    s_mov_b32 s26, 524288
    s_mov_b32 s27, 0x20000
    s_add_u32 s56, s42, s43
    v_lshl_add_u32 v5, s44, 2, v2
    v_xor_b32 v5, v5, v3
    v_lshlrev_b32 v5, 4, v5
    v_lshl_add_u32 v5, v2, 10, v5
    v_lshlrev_b32 v6, 2, v2
    v_and_b32 v6, 4, v6
    v_xor_b32 v6, v6, v7
    v_lshlrev_b32 v6, 4, v6
    v_lshrrev_b32 v8, 3, v0
    v_lshl_add_u32 v6, v8, 10, v6
    s_lshl4_add_u32 s47, s42, s44
    s_lshl_b32 s47, s47, 12
    s_lshl_b32 s49, s44, 10
    s_lshl_b32 s48, s43, 7
    s_lshl3_add_u32 s48, s49, s48
    s_and_b32 s50, s56, 3
    s_lshl_b32 s51, s50, 8
    s_add_u32 s51, s51, s47
    s_lshl_b32 s52, s50, 17
    s_add_u32 s52, s52, s48
    s_and_b32 s53, s43, 0
    s_lshl_b32 s62, s53, 11
    s_add_u32 s61, s62, s49
    s_xor_b32 s62, s61, 8192
    s_lshl_b32 s53, s53, 13
    s_add_u32 s54, s51, s53
    s_xor_b32 s55, s54, 32768
    s_lshl_b32 s50, s50, 12
    s_waitcnt lgkmcnt(0)
    s_mov_b64 s[24:25], s[10:11]
    s_mov_b32 s10, 2097152
    s_mov_b32 s11, 0x20000
    s_add_u32 m0, s61, 0
    s_add_u32 s53, s54, 0
    buffer_load_dwordx4 v5, s[8:11], s53 offen lds
    s_add_u32 m0, s49, 65536
    s_add_u32 s53, s52, 0
    buffer_load_dwordx4 v6, s[24:27], s53 offen lds
    s_add_u32 m0, s61, 4096
    s_add_u32 s53, s54, 16384
    buffer_load_dwordx4 v5, s[8:11], s53 offen lds
    s_add_u32 m0, s49, 69632
    s_add_u32 s53, s52, 32768
    buffer_load_dwordx4 v6, s[24:27], s53 offen lds
    s_cmp_eq_u32 s43, 0
    s_cselect_b64 s[12:13], s[12:13], s[14:15]
    s_mov_b64 s[32:33], s[34:35]
    s_mov_b32 s18, 524288
    s_mov_b32 s19, 0x20000
    s_mov_b32 s22, 1024
    s_mov_b32 s23, 0x20000
    s_mov_b32 s30, 1024
    s_mov_b32 s31, 0x20000
    s_mov_b32 s14, 16384
    s_mov_b32 s15, 0x20000
    s_mov_b32 s34, 2842624
    s_mov_b32 s35, 0x20000
    v_lshlrev_b32 v4, 4, v0
    s_sub_u32 s58, s43, 3
    s_lshl_b32 s58, s58, 5
    s_add_u32 s58, s58, s42
    s_lshr_b32 s59, s58, 4
    s_lshl_b32 s59, s59, 16
    s_and_b32 s53, s58, 3
    s_lshl_b32 s53, s53, 14
    s_add_u32 s59, s59, s53
    s_bfe_u32 s53, s58, 0x20002
    s_lshl_b32 s53, s53, 8
    s_add_u32 s59, s59, s53
    v_lshlrev_b32 v9, 4, v3
    v_lshl_add_u32 v9, v2, 13, v9
    v_add_u32 v10, 4096, v9
    s_lshl_b32 s53, s56, 8
    v_add_u32 v11, s53, v4
    v_and_b32 v11, 1023, v11
    s_mov_b32 m0, 131072
    s_cmp_lt_u32 s43, 2
    s_cbranch_scc1 K1_prodkv
    s_cmp_lg_u32 s44, 0
    s_cbranch_scc1 K1_prod
    s_cmp_eq_u32 s43, 7
    s_cbranch_scc1 K1_prod
    s_cmp_eq_u32 s43, 2
    s_cbranch_scc1 K1_exrg
    s_mov_b32 exec_hi, 0
    buffer_load_dwordx4 v[64:67], v9, s[16:19], s59 offen offset:0
    buffer_load_dwordx4 v[68:71], v9, s[16:19], s59 offen offset:1024
    buffer_load_dwordx4 v[72:75], v9, s[16:19], s59 offen offset:2048
    buffer_load_dwordx4 v[76:79], v9, s[16:19], s59 offen offset:3072
    buffer_load_dwordx4 v[80:83], v10, s[16:19], s59 offen offset:0
    buffer_load_dwordx4 v[84:87], v10, s[16:19], s59 offen offset:1024
    buffer_load_dwordx4 v[88:91], v10, s[16:19], s59 offen offset:2048
    buffer_load_dwordx4 v[92:95], v10, s[16:19], s59 offen offset:3072
    s_mov_b64 exec, -1
    s_branch K1_prod
K1_exrg:
    buffer_load_dwordx4 v11, s[20:23], 0 offen lds
    s_mov_b32 m0, 132096
    s_nop 0
    buffer_load_dwordx4 v11, s[28:31], 0 offen lds
K1_prod:
    s_add_u32 m0, s62, 0
    s_add_u32 s53, s55, 0
    buffer_load_dwordx4 v5, s[8:11], s53 offen lds
    s_add_u32 m0, s49, 73728
    s_add_u32 s53, s52, 65536
    buffer_load_dwordx4 v6, s[24:27], s53 offen lds
    s_add_u32 m0, s62, 4096
    s_add_u32 s53, s55, 16384
    buffer_load_dwordx4 v5, s[8:11], s53 offen lds
    s_add_u32 m0, s49, 77824
    s_add_u32 s53, s52, 98304
    buffer_load_dwordx4 v6, s[24:27], s53 offen lds
    s_add_u32 s50, s56, 1
    s_and_b32 s50, s50, 3
    s_lshl_b32 s51, s50, 8
    s_add_u32 s51, s51, s47
    s_lshl_b32 s52, s50, 17
    s_add_u32 s52, s52, s48
    s_add_u32 m0, s49, 16384
    s_lshl_b32 s50, s50, 12
    buffer_load_dwordx4 v5, s[8:11], s51 offen lds
    s_add_u32 m0, s49, 81920
    s_add_u32 s51, s51, 16384
    buffer_load_dwordx4 v6, s[24:27], s52 offen lds
    s_add_u32 m0, s49, 20480
    s_add_u32 s52, s52, 32768
    buffer_load_dwordx4 v5, s[8:11], s51 offen lds
    s_add_u32 m0, s49, 86016
    s_add_u32 s51, s51, 16384
    buffer_load_dwordx4 v6, s[24:27], s52 offen lds
    s_add_u32 m0, s49, 24576
    s_add_u32 s52, s52, 32768
    buffer_load_dwordx4 v5, s[8:11], s51 offen lds
    s_add_u32 m0, s49, 90112
    s_add_u32 s51, s51, 16384
    buffer_load_dwordx4 v6, s[24:27], s52 offen lds
    s_add_u32 m0, s49, 28672
    s_add_u32 s52, s52, 32768
    buffer_load_dwordx4 v5, s[8:11], s51 offen lds
    s_add_u32 m0, s49, 94208
    s_add_u32 s51, s51, 16384
    buffer_load_dwordx4 v6, s[24:27], s52 offen lds
    s_waitcnt vmcnt(8)
    s_barrier
    s_add_u32 s50, s56, 2
    s_and_b32 s50, s50, 3
    s_lshl_b32 s51, s50, 8
    s_add_u32 s51, s51, s47
    s_lshl_b32 s52, s50, 17
    s_add_u32 s52, s52, s48
    s_add_u32 m0, s49, 32768
    s_lshl_b32 s50, s50, 12
    buffer_load_dwordx4 v5, s[8:11], s51 offen lds
    s_add_u32 m0, s49, 98304
    s_add_u32 s51, s51, 16384
    buffer_load_dwordx4 v6, s[24:27], s52 offen lds
    s_add_u32 m0, s49, 36864
    s_add_u32 s52, s52, 32768
    buffer_load_dwordx4 v5, s[8:11], s51 offen lds
    s_add_u32 m0, s49, 102400
    s_add_u32 s51, s51, 16384
    buffer_load_dwordx4 v6, s[24:27], s52 offen lds
    s_add_u32 m0, s49, 40960
    s_add_u32 s52, s52, 32768
    buffer_load_dwordx4 v5, s[8:11], s51 offen lds
    s_add_u32 m0, s49, 106496
    s_add_u32 s51, s51, 16384
    buffer_load_dwordx4 v6, s[24:27], s52 offen lds
    s_add_u32 m0, s49, 45056
    s_add_u32 s52, s52, 32768
    buffer_load_dwordx4 v5, s[8:11], s51 offen lds
    s_add_u32 m0, s49, 110592
    s_add_u32 s51, s51, 16384
    buffer_load_dwordx4 v6, s[24:27], s52 offen lds
    s_waitcnt vmcnt(8)
    s_barrier
    s_add_u32 s50, s56, 3
    s_and_b32 s50, s50, 3
    s_lshl_b32 s51, s50, 8
    s_add_u32 s51, s51, s47
    s_lshl_b32 s52, s50, 17
    s_add_u32 s52, s52, s48
    s_add_u32 m0, s49, 49152
    s_lshl_b32 s50, s50, 12
    buffer_load_dwordx4 v5, s[8:11], s51 offen lds
    s_add_u32 m0, s49, 114688
    s_add_u32 s51, s51, 16384
    buffer_load_dwordx4 v6, s[24:27], s52 offen lds
    s_add_u32 m0, s49, 53248
    s_add_u32 s52, s52, 32768
    buffer_load_dwordx4 v5, s[8:11], s51 offen lds
    s_add_u32 m0, s49, 118784
    s_add_u32 s51, s51, 16384
    buffer_load_dwordx4 v6, s[24:27], s52 offen lds
    s_add_u32 m0, s49, 57344
    s_add_u32 s52, s52, 32768
    buffer_load_dwordx4 v5, s[8:11], s51 offen lds
    s_add_u32 m0, s49, 122880
    s_add_u32 s51, s51, 16384
    buffer_load_dwordx4 v6, s[24:27], s52 offen lds
    s_add_u32 m0, s49, 61440
    s_add_u32 s52, s52, 32768
    buffer_load_dwordx4 v5, s[8:11], s51 offen lds
    s_add_u32 m0, s49, 126976
    s_add_u32 s51, s51, 16384
    buffer_load_dwordx4 v6, s[24:27], s52 offen lds
    s_waitcnt vmcnt(8)
    s_barrier
    s_waitcnt vmcnt(0)
    s_barrier
    s_cmp_eq_u32 s43, 7
    s_cbranch_scc1 K1_zero
    s_cmp_lg_u32 s44, 0
    s_cbranch_scc1 K1_exit
    s_cmp_eq_u32 s43, 2
    s_cbranch_scc1 K1_exit
    s_mov_b32 s54, 0x05040100
    s_mov_b32 s55, 0x07060302
    s_lshr_b32 s51, s58, 2
    s_lshl_b32 s51, s51, 14
    s_and_b32 s52, s58, 3
    s_lshl_b32 s52, s52, 9
    s_add_u32 s51, s51, s52
    s_add_u32 s51, s51, 2228224
    s_mov_b32 exec_hi, 0
    v_perm_b32 v96, v68, v64, s54
    v_perm_b32 v97, v84, v80, s54
    v_perm_b32 v98, v76, v72, s54
    v_perm_b32 v99, v92, v88, s54
    buffer_store_dwordx4 v[96:99], v4, s[32:35], s51 offen offset:0
    v_perm_b32 v100, v68, v64, s55
    v_perm_b32 v101, v84, v80, s55
    v_perm_b32 v102, v76, v72, s55
    v_perm_b32 v103, v92, v88, s55
    buffer_store_dwordx4 v[100:103], v4, s[32:35], s51 offen offset:2048
    s_add_u32 s51, s51, 4096
    v_perm_b32 v104, v69, v65, s54
    v_perm_b32 v105, v85, v81, s54
    v_perm_b32 v106, v77, v73, s54
    v_perm_b32 v107, v93, v89, s54
    buffer_store_dwordx4 v[104:107], v4, s[32:35], s51 offen offset:0
    v_perm_b32 v108, v69, v65, s55
    v_perm_b32 v109, v85, v81, s55
    v_perm_b32 v110, v77, v73, s55
    v_perm_b32 v111, v93, v89, s55
    buffer_store_dwordx4 v[108:111], v4, s[32:35], s51 offen offset:2048
    s_add_u32 s51, s51, 4096
    v_perm_b32 v112, v70, v66, s54
    v_perm_b32 v113, v86, v82, s54
    v_perm_b32 v114, v78, v74, s54
    v_perm_b32 v115, v94, v90, s54
    buffer_store_dwordx4 v[112:115], v4, s[32:35], s51 offen offset:0
    v_perm_b32 v116, v70, v66, s55
    v_perm_b32 v117, v86, v82, s55
    v_perm_b32 v118, v78, v74, s55
    v_perm_b32 v119, v94, v90, s55
    buffer_store_dwordx4 v[116:119], v4, s[32:35], s51 offen offset:2048
    s_add_u32 s51, s51, 4096
    v_perm_b32 v120, v71, v67, s54
    v_perm_b32 v121, v87, v83, s54
    v_perm_b32 v122, v79, v75, s54
    v_perm_b32 v123, v95, v91, s54
    buffer_store_dwordx4 v[120:123], v4, s[32:35], s51 offen offset:0
    v_perm_b32 v124, v71, v67, s55
    v_perm_b32 v125, v87, v83, s55
    v_perm_b32 v126, v79, v75, s55
    v_perm_b32 v127, v95, v91, s55
    buffer_store_dwordx4 v[124:127], v4, s[32:35], s51 offen offset:2048
    s_endpgm
K1_zero:
    s_lshl_b32 s50, s42, 2
    s_add_u32 s50, s50, s44
    s_cmp_lt_u32 s50, 72
    s_cbranch_scc0 K1_exit
    v_mov_b32 v64, 0
    v_mov_b32 v65, 0
    v_mov_b32 v66, 0
    v_mov_b32 v67, 0
    s_lshl_b32 s50, s50, 10
    s_add_u32 s51, s50, 2768896
    buffer_store_dwordx4 v[64:67], v4, s[32:35], s51 offen sc1
K1_exit:
    s_endpgm
K1_prodkv:
    s_add_u32 m0, s62, 0
    s_add_u32 s53, s55, 0
    buffer_load_dwordx4 v5, s[8:11], s53 offen lds
    s_add_u32 m0, s49, 73728
    s_add_u32 s53, s52, 65536
    buffer_load_dwordx4 v6, s[24:27], s53 offen lds
    s_add_u32 m0, s62, 4096
    s_add_u32 s53, s55, 16384
    buffer_load_dwordx4 v5, s[8:11], s53 offen lds
    s_add_u32 m0, s49, 77824
    s_add_u32 s53, s52, 98304
    buffer_load_dwordx4 v6, s[24:27], s53 offen lds
    s_add_u32 m0, s49, 131072
    s_add_u32 s50, s50, s49
    buffer_load_dwordx4 v4, s[12:15], s50 offen lds
    s_add_u32 s50, s56, 1
    s_and_b32 s50, s50, 3
    s_lshl_b32 s51, s50, 8
    s_add_u32 s51, s51, s47
    s_lshl_b32 s52, s50, 17
    s_add_u32 s52, s52, s48
    s_add_u32 m0, s49, 16384
    s_lshl_b32 s50, s50, 12
    buffer_load_dwordx4 v5, s[8:11], s51 offen lds
    s_add_u32 m0, s49, 81920
    s_add_u32 s51, s51, 16384
    buffer_load_dwordx4 v6, s[24:27], s52 offen lds
    s_add_u32 m0, s49, 20480
    s_add_u32 s52, s52, 32768
    buffer_load_dwordx4 v5, s[8:11], s51 offen lds
    s_add_u32 m0, s49, 86016
    s_add_u32 s51, s51, 16384
    buffer_load_dwordx4 v6, s[24:27], s52 offen lds
    s_add_u32 m0, s49, 24576
    s_add_u32 s52, s52, 32768
    buffer_load_dwordx4 v5, s[8:11], s51 offen lds
    s_add_u32 m0, s49, 90112
    s_add_u32 s51, s51, 16384
    buffer_load_dwordx4 v6, s[24:27], s52 offen lds
    s_add_u32 m0, s49, 28672
    s_add_u32 s52, s52, 32768
    buffer_load_dwordx4 v5, s[8:11], s51 offen lds
    s_add_u32 m0, s49, 94208
    s_add_u32 s51, s51, 16384
    buffer_load_dwordx4 v6, s[24:27], s52 offen lds
    s_add_u32 m0, s49, 135168
    s_add_u32 s50, s50, s49
    buffer_load_dwordx4 v4, s[12:15], s50 offen lds
    s_waitcnt vmcnt(9)
    s_barrier
    s_add_u32 s50, s56, 2
    s_and_b32 s50, s50, 3
    s_lshl_b32 s51, s50, 8
    s_add_u32 s51, s51, s47
    s_lshl_b32 s52, s50, 17
    s_add_u32 s52, s52, s48
    s_add_u32 m0, s49, 32768
    s_lshl_b32 s50, s50, 12
    buffer_load_dwordx4 v5, s[8:11], s51 offen lds
    s_add_u32 m0, s49, 98304
    s_add_u32 s51, s51, 16384
    buffer_load_dwordx4 v6, s[24:27], s52 offen lds
    s_add_u32 m0, s49, 36864
    s_add_u32 s52, s52, 32768
    buffer_load_dwordx4 v5, s[8:11], s51 offen lds
    s_add_u32 m0, s49, 102400
    s_add_u32 s51, s51, 16384
    buffer_load_dwordx4 v6, s[24:27], s52 offen lds
    s_add_u32 m0, s49, 40960
    s_add_u32 s52, s52, 32768
    buffer_load_dwordx4 v5, s[8:11], s51 offen lds
    s_add_u32 m0, s49, 106496
    s_add_u32 s51, s51, 16384
    buffer_load_dwordx4 v6, s[24:27], s52 offen lds
    s_add_u32 m0, s49, 45056
    s_add_u32 s52, s52, 32768
    buffer_load_dwordx4 v5, s[8:11], s51 offen lds
    s_add_u32 m0, s49, 110592
    s_add_u32 s51, s51, 16384
    buffer_load_dwordx4 v6, s[24:27], s52 offen lds
    s_add_u32 m0, s49, 139264
    s_add_u32 s50, s50, s49
    buffer_load_dwordx4 v4, s[12:15], s50 offen lds
    s_waitcnt vmcnt(9)
    s_barrier
    s_add_u32 s50, s56, 3
    s_and_b32 s50, s50, 3
    s_lshl_b32 s51, s50, 8
    s_add_u32 s51, s51, s47
    s_lshl_b32 s52, s50, 17
    s_add_u32 s52, s52, s48
    s_add_u32 m0, s49, 49152
    s_lshl_b32 s50, s50, 12
    buffer_load_dwordx4 v5, s[8:11], s51 offen lds
    s_add_u32 m0, s49, 114688
    s_add_u32 s51, s51, 16384
    buffer_load_dwordx4 v6, s[24:27], s52 offen lds
    s_add_u32 m0, s49, 53248
    s_add_u32 s52, s52, 32768
    buffer_load_dwordx4 v5, s[8:11], s51 offen lds
    s_add_u32 m0, s49, 118784
    s_add_u32 s51, s51, 16384
    buffer_load_dwordx4 v6, s[24:27], s52 offen lds
    s_add_u32 m0, s49, 57344
    s_add_u32 s52, s52, 32768
    buffer_load_dwordx4 v5, s[8:11], s51 offen lds
    s_add_u32 m0, s49, 122880
    s_add_u32 s51, s51, 16384
    buffer_load_dwordx4 v6, s[24:27], s52 offen lds
    s_add_u32 m0, s49, 61440
    s_add_u32 s52, s52, 32768
    buffer_load_dwordx4 v5, s[8:11], s51 offen lds
    s_add_u32 m0, s49, 126976
    s_add_u32 s51, s51, 16384
    buffer_load_dwordx4 v6, s[24:27], s52 offen lds
    s_add_u32 m0, s49, 143360
    s_add_u32 s50, s50, s49
    buffer_load_dwordx4 v4, s[12:15], s50 offen lds
    s_waitcnt vmcnt(9)
    s_barrier
    s_waitcnt vmcnt(0)
    s_barrier
    s_endpgm
K1_main:
    s_and_b32 s50, s44, 1
    s_lshr_b32 s51, s44, 1
    v_and_b32 v12, 31, v0
    v_lshrrev_b32 v13, 5, v0
    s_lshl_b32 s52, s50, 13
    v_lshl_add_u32 v14, v12, 8, s52
    v_xor_b32 v15, v13, v3
    v_xor_b32 v16, 0, v15
    v_lshl_add_u32 v16, v16, 4, v14
    v_xor_b32 v17, 2, v15
    v_lshl_add_u32 v17, v17, 4, v14
    v_xor_b32 v18, 4, v15
    v_lshl_add_u32 v18, v18, 4, v14
    v_xor_b32 v19, 6, v15
    v_lshl_add_u32 v19, v19, 4, v14
    v_xor_b32 v20, 8, v15
    v_lshl_add_u32 v20, v20, 4, v14
    v_xor_b32 v21, 10, v15
    v_lshl_add_u32 v21, v21, 4, v14
    v_xor_b32 v22, 12, v15
    v_lshl_add_u32 v22, v22, 4, v14
    v_xor_b32 v23, 14, v15
    v_lshl_add_u32 v23, v23, 4, v14
    v_bfe_u32 v28, v0, 2, 2
    v_lshl_add_u32 v25, v13, 3, v28
    v_and_b32 v29, 3, v0
    v_lshlrev_b32 v29, 3, v29
    v_and_b32 v27, 1, v2
    v_lshl_add_u32 v26, v27, 5, v29
    s_lshl_b32 s52, s51, 6
    v_add_u32 v26, s52, v26
    v_lshrrev_b32 v27, 1, v28
    v_lshlrev_b32 v27, 6, v27
    v_xor_b32 v26, v26, v27
    v_lshl_add_u32 v24, v25, 7, v26
    v_add_u32 v24, 65536, v24
    v_lshrrev_b32 v25, 3, v12
    v_lshlrev_b32 v25, 13, v25
    v_lshl_add_u32 v25, v13, 9, v25
    v_lshl_add_u32 v25, v7, 4, v25
    s_lshl_b32 s52, s42, 16
    s_lshl_b32 s53, s50, 15
    s_add_u32 s52, s52, s53
    s_lshl_b32 s53, s43, 10
    s_add_u32 s52, s52, s53
    s_lshl_b32 s53, s51, 8
    s_add_u32 s52, s52, s53
    s_lshl_b32 s53, s44, 12
    v_lshl_add_u32 v14, v3, 8, s53
    v_xor_b32 v15, v2, v3
    v_xor_b32 v8, 0, v15
    v_lshl_add_u32 v8, v8, 4, v14
    v_xor_b32 v9, 4, v15
    v_lshl_add_u32 v9, v9, 4, v14
    v_xor_b32 v10, 8, v15
    v_lshl_add_u32 v10, v10, 4, v14
    v_xor_b32 v11, 12, v15
    v_lshl_add_u32 v11, v11, 4, v14
    v_lshl_add_u32 v26, v2, 3, v28
    v_lshl_add_u32 v26, v26, 5, v29
    v_add_u32 v26, 131072, v26
    s_lshl_b32 s54, s42, 1
    s_add_u32 s54, s54, s51
    s_lshl_b32 s54, s54, 11
    s_add_u32 s54, s54, 2097152
    s_lshl_b32 s50, s50, 8
    s_add_u32 s54, s54, s50
    v_and_b32 v12, 1, v2
    v_lshrrev_b32 v13, 1, v2
    v_lshlrev_b32 v14, 4, v3
    s_setprio 1
    s_waitcnt lgkmcnt(0)
    s_mov_b64 s[32:33], s[34:35]
    s_mov_b32 s34, 2842624
    s_mov_b32 s35, 0x20000
    s_cmp_eq_u32 s43, 0
    s_cbranch_scc1 K1_k
    s_cmp_eq_u32 s43, 1
    s_cbranch_scc1 K1_v
    s_cmp_eq_u32 s43, 2
    s_cbranch_scc1 K1_rg
    s_barrier
    ds_read_b128 v[48:51], v16 offset:0
    ds_read_b64_tr_b16 v[80:81], v24 offset:0
    ds_read_b64_tr_b16 v[82:83], v24 offset:512
    ds_read_b128 v[52:55], v17 offset:0
    ds_read_b64_tr_b16 v[84:85], v24 offset:2048
    ds_read_b64_tr_b16 v[86:87], v24 offset:2560
    ds_read_b128 v[56:59], v18 offset:0
    ds_read_b64_tr_b16 v[88:89], v24 offset:4096
    ds_read_b64_tr_b16 v[90:91], v24 offset:4608
    ds_read_b128 v[60:63], v19 offset:0
    ds_read_b64_tr_b16 v[92:93], v24 offset:6144
    ds_read_b64_tr_b16 v[94:95], v24 offset:6656
    s_waitcnt lgkmcnt(9)
    v_mfma_f32_32x32x16_bf16 v[32:47], v[80:83], v[48:51], 0
    ds_read_b128 v[64:67], v20 offset:0
    ds_read_b64_tr_b16 v[96:97], v24 offset:8192
    ds_read_b64_tr_b16 v[98:99], v24 offset:8704
    s_waitcnt lgkmcnt(9)
    v_mfma_f32_32x32x16_bf16 v[32:47], v[84:87], v[52:55], v[32:47]
    ds_read_b128 v[68:71], v21 offset:0
    ds_read_b64_tr_b16 v[100:101], v24 offset:10240
    ds_read_b64_tr_b16 v[102:103], v24 offset:10752
    s_waitcnt lgkmcnt(9)
    v_mfma_f32_32x32x16_bf16 v[32:47], v[88:91], v[56:59], v[32:47]
    ds_read_b128 v[72:75], v22 offset:0
    ds_read_b64_tr_b16 v[104:105], v24 offset:12288
    ds_read_b64_tr_b16 v[106:107], v24 offset:12800
    s_waitcnt lgkmcnt(9)
    v_mfma_f32_32x32x16_bf16 v[32:47], v[92:95], v[60:63], v[32:47]
    ds_read_b128 v[76:79], v23 offset:0
    ds_read_b64_tr_b16 v[108:109], v24 offset:14336
    ds_read_b64_tr_b16 v[110:111], v24 offset:14848
    s_waitcnt lgkmcnt(9)
    v_mfma_f32_32x32x16_bf16 v[32:47], v[96:99], v[64:67], v[32:47]
    s_waitcnt lgkmcnt(6)
    v_mfma_f32_32x32x16_bf16 v[32:47], v[100:103], v[68:71], v[32:47]
    s_waitcnt lgkmcnt(3)
    v_mfma_f32_32x32x16_bf16 v[32:47], v[104:107], v[72:75], v[32:47]
    s_waitcnt lgkmcnt(0)
    v_mfma_f32_32x32x16_bf16 v[32:47], v[108:111], v[76:79], v[32:47]
    s_barrier
    ds_read_b128 v[48:51], v16 offset:16384
    ds_read_b64_tr_b16 v[80:81], v24 offset:16384
    ds_read_b64_tr_b16 v[82:83], v24 offset:16896
    ds_read_b128 v[52:55], v17 offset:16384
    ds_read_b64_tr_b16 v[84:85], v24 offset:18432
    ds_read_b64_tr_b16 v[86:87], v24 offset:18944
    ds_read_b128 v[56:59], v18 offset:16384
    ds_read_b64_tr_b16 v[88:89], v24 offset:20480
    ds_read_b64_tr_b16 v[90:91], v24 offset:20992
    ds_read_b128 v[60:63], v19 offset:16384
    ds_read_b64_tr_b16 v[92:93], v24 offset:22528
    ds_read_b64_tr_b16 v[94:95], v24 offset:23040
    s_waitcnt lgkmcnt(9)
    v_mfma_f32_32x32x16_bf16 v[32:47], v[80:83], v[48:51], v[32:47]
    ds_read_b128 v[64:67], v20 offset:16384
    ds_read_b64_tr_b16 v[96:97], v24 offset:24576
    ds_read_b64_tr_b16 v[98:99], v24 offset:25088
    s_waitcnt lgkmcnt(9)
    v_mfma_f32_32x32x16_bf16 v[32:47], v[84:87], v[52:55], v[32:47]
    ds_read_b128 v[68:71], v21 offset:16384
    ds_read_b64_tr_b16 v[100:101], v24 offset:26624
    ds_read_b64_tr_b16 v[102:103], v24 offset:27136
    s_waitcnt lgkmcnt(9)
    v_mfma_f32_32x32x16_bf16 v[32:47], v[88:91], v[56:59], v[32:47]
    ds_read_b128 v[72:75], v22 offset:16384
    ds_read_b64_tr_b16 v[104:105], v24 offset:28672
    ds_read_b64_tr_b16 v[106:107], v24 offset:29184
    s_waitcnt lgkmcnt(9)
    v_mfma_f32_32x32x16_bf16 v[32:47], v[92:95], v[60:63], v[32:47]
    ds_read_b128 v[76:79], v23 offset:16384
    ds_read_b64_tr_b16 v[108:109], v24 offset:30720
    ds_read_b64_tr_b16 v[110:111], v24 offset:31232
    s_waitcnt lgkmcnt(9)
    v_mfma_f32_32x32x16_bf16 v[32:47], v[96:99], v[64:67], v[32:47]
    s_waitcnt lgkmcnt(6)
    v_mfma_f32_32x32x16_bf16 v[32:47], v[100:103], v[68:71], v[32:47]
    s_waitcnt lgkmcnt(3)
    v_mfma_f32_32x32x16_bf16 v[32:47], v[104:107], v[72:75], v[32:47]
    s_waitcnt lgkmcnt(0)
    v_mfma_f32_32x32x16_bf16 v[32:47], v[108:111], v[76:79], v[32:47]
    s_barrier
    ds_read_b128 v[48:51], v16 offset:32768
    ds_read_b64_tr_b16 v[80:81], v24 offset:32768
    ds_read_b64_tr_b16 v[82:83], v24 offset:33280
    ds_read_b128 v[52:55], v17 offset:32768
    ds_read_b64_tr_b16 v[84:85], v24 offset:34816
    ds_read_b64_tr_b16 v[86:87], v24 offset:35328
    ds_read_b128 v[56:59], v18 offset:32768
    ds_read_b64_tr_b16 v[88:89], v24 offset:36864
    ds_read_b64_tr_b16 v[90:91], v24 offset:37376
    ds_read_b128 v[60:63], v19 offset:32768
    ds_read_b64_tr_b16 v[92:93], v24 offset:38912
    ds_read_b64_tr_b16 v[94:95], v24 offset:39424
    s_waitcnt lgkmcnt(9)
    v_mfma_f32_32x32x16_bf16 v[32:47], v[80:83], v[48:51], v[32:47]
    ds_read_b128 v[64:67], v20 offset:32768
    ds_read_b64_tr_b16 v[96:97], v24 offset:40960
    ds_read_b64_tr_b16 v[98:99], v24 offset:41472
    s_waitcnt lgkmcnt(9)
    v_mfma_f32_32x32x16_bf16 v[32:47], v[84:87], v[52:55], v[32:47]
    ds_read_b128 v[68:71], v21 offset:32768
    ds_read_b64_tr_b16 v[100:101], v24 offset:43008
    ds_read_b64_tr_b16 v[102:103], v24 offset:43520
    s_waitcnt lgkmcnt(9)
    v_mfma_f32_32x32x16_bf16 v[32:47], v[88:91], v[56:59], v[32:47]
    ds_read_b128 v[72:75], v22 offset:32768
    ds_read_b64_tr_b16 v[104:105], v24 offset:45056
    ds_read_b64_tr_b16 v[106:107], v24 offset:45568
    s_waitcnt lgkmcnt(9)
    v_mfma_f32_32x32x16_bf16 v[32:47], v[92:95], v[60:63], v[32:47]
    ds_read_b128 v[76:79], v23 offset:32768
    ds_read_b64_tr_b16 v[108:109], v24 offset:47104
    ds_read_b64_tr_b16 v[110:111], v24 offset:47616
    s_waitcnt lgkmcnt(9)
    v_mfma_f32_32x32x16_bf16 v[32:47], v[96:99], v[64:67], v[32:47]
    s_waitcnt lgkmcnt(6)
    v_mfma_f32_32x32x16_bf16 v[32:47], v[100:103], v[68:71], v[32:47]
    s_waitcnt lgkmcnt(3)
    v_mfma_f32_32x32x16_bf16 v[32:47], v[104:107], v[72:75], v[32:47]
    s_waitcnt lgkmcnt(0)
    v_mfma_f32_32x32x16_bf16 v[32:47], v[108:111], v[76:79], v[32:47]
    s_barrier
    ds_read_b128 v[48:51], v16 offset:49152
    ds_read_b64_tr_b16 v[80:81], v24 offset:49152
    ds_read_b64_tr_b16 v[82:83], v24 offset:49664
    ds_read_b128 v[52:55], v17 offset:49152
    ds_read_b64_tr_b16 v[84:85], v24 offset:51200
    ds_read_b64_tr_b16 v[86:87], v24 offset:51712
    ds_read_b128 v[56:59], v18 offset:49152
    ds_read_b64_tr_b16 v[88:89], v24 offset:53248
    ds_read_b64_tr_b16 v[90:91], v24 offset:53760
    ds_read_b128 v[60:63], v19 offset:49152
    ds_read_b64_tr_b16 v[92:93], v24 offset:55296
    ds_read_b64_tr_b16 v[94:95], v24 offset:55808
    s_waitcnt lgkmcnt(9)
    v_mfma_f32_32x32x16_bf16 v[32:47], v[80:83], v[48:51], v[32:47]
    ds_read_b128 v[64:67], v20 offset:49152
    ds_read_b64_tr_b16 v[96:97], v24 offset:57344
    ds_read_b64_tr_b16 v[98:99], v24 offset:57856
    s_waitcnt lgkmcnt(9)
    v_mfma_f32_32x32x16_bf16 v[32:47], v[84:87], v[52:55], v[32:47]
    ds_read_b128 v[68:71], v21 offset:49152
    ds_read_b64_tr_b16 v[100:101], v24 offset:59392
    ds_read_b64_tr_b16 v[102:103], v24 offset:59904
    s_waitcnt lgkmcnt(9)
    v_mfma_f32_32x32x16_bf16 v[32:47], v[88:91], v[56:59], v[32:47]
    ds_read_b128 v[72:75], v22 offset:49152
    ds_read_b64_tr_b16 v[104:105], v24 offset:61440
    ds_read_b64_tr_b16 v[106:107], v24 offset:61952
    s_waitcnt lgkmcnt(9)
    v_mfma_f32_32x32x16_bf16 v[32:47], v[92:95], v[60:63], v[32:47]
    ds_read_b128 v[76:79], v23 offset:49152
    ds_read_b64_tr_b16 v[108:109], v24 offset:63488
    ds_read_b64_tr_b16 v[110:111], v24 offset:64000
    s_waitcnt lgkmcnt(9)
    v_mfma_f32_32x32x16_bf16 v[32:47], v[96:99], v[64:67], v[32:47]
    s_waitcnt lgkmcnt(6)
    v_mfma_f32_32x32x16_bf16 v[32:47], v[100:103], v[68:71], v[32:47]
    s_waitcnt lgkmcnt(3)
    v_mfma_f32_32x32x16_bf16 v[32:47], v[104:107], v[72:75], v[32:47]
    s_waitcnt lgkmcnt(0)
    v_mfma_f32_32x32x16_bf16 v[32:47], v[108:111], v[76:79], v[32:47]
    s_nop 11
    v_cvt_pk_bf16_f32 v48, v32, v33
    v_cvt_pk_bf16_f32 v49, v34, v35
    v_cvt_pk_bf16_f32 v50, v36, v37
    v_cvt_pk_bf16_f32 v51, v38, v39
    buffer_store_dwordx4 v[48:51], v25, s[32:35], s52 offen
    v_cvt_pk_bf16_f32 v52, v40, v41
    v_cvt_pk_bf16_f32 v53, v42, v43
    v_cvt_pk_bf16_f32 v54, v44, v45
    v_cvt_pk_bf16_f32 v55, v46, v47
    buffer_store_dwordx4 v[52:55], v25, s[32:35], s52 offen offset:128
    s_endpgm
K1_k:
    v_lshl_add_u32 v14, v12, 9, v14
    v_lshl_add_u32 v14, v13, 3, v14
    s_barrier
    ds_read_b128 v[48:51], v16 offset:0
    ds_read_b64_tr_b16 v[80:81], v24 offset:0
    ds_read_b64_tr_b16 v[82:83], v24 offset:512
    ds_read_b128 v[52:55], v17 offset:0
    ds_read_b64_tr_b16 v[84:85], v24 offset:2048
    ds_read_b64_tr_b16 v[86:87], v24 offset:2560
    ds_read_b128 v[56:59], v18 offset:0
    ds_read_b64_tr_b16 v[88:89], v24 offset:4096
    ds_read_b64_tr_b16 v[90:91], v24 offset:4608
    ds_read_b128 v[60:63], v19 offset:0
    ds_read_b64_tr_b16 v[92:93], v24 offset:6144
    ds_read_b64_tr_b16 v[94:95], v24 offset:6656
    s_waitcnt lgkmcnt(9)
    v_mfma_f32_32x32x16_bf16 v[32:47], v[80:83], v[48:51], 0
    ds_read_b128 v[64:67], v20 offset:0
    ds_read_b64_tr_b16 v[96:97], v24 offset:8192
    ds_read_b64_tr_b16 v[98:99], v24 offset:8704
    s_waitcnt lgkmcnt(9)
    v_mfma_f32_32x32x16_bf16 v[32:47], v[84:87], v[52:55], v[32:47]
    ds_read_b128 v[68:71], v21 offset:0
    ds_read_b64_tr_b16 v[100:101], v24 offset:10240
    ds_read_b64_tr_b16 v[102:103], v24 offset:10752
    s_waitcnt lgkmcnt(9)
    v_mfma_f32_32x32x16_bf16 v[32:47], v[88:91], v[56:59], v[32:47]
    ds_read_b128 v[72:75], v22 offset:0
    ds_read_b64_tr_b16 v[104:105], v24 offset:12288
    ds_read_b64_tr_b16 v[106:107], v24 offset:12800
    s_waitcnt lgkmcnt(9)
    v_mfma_f32_32x32x16_bf16 v[32:47], v[92:95], v[60:63], v[32:47]
    ds_read_b128 v[76:79], v23 offset:0
    ds_read_b64_tr_b16 v[108:109], v24 offset:14336
    ds_read_b64_tr_b16 v[110:111], v24 offset:14848
    s_waitcnt lgkmcnt(9)
    v_mfma_f32_32x32x16_bf16 v[32:47], v[96:99], v[64:67], v[32:47]
    ds_read_b128 v[112:115], v8 offset:0
    ds_read_b64_tr_b16 v[128:129], v26 offset:0
    ds_read_b64_tr_b16 v[130:131], v26 offset:128
    s_waitcnt lgkmcnt(9)
    v_mfma_f32_32x32x16_bf16 v[32:47], v[100:103], v[68:71], v[32:47]
    ds_read_b128 v[116:119], v9 offset:0
    ds_read_b64_tr_b16 v[132:133], v26 offset:1024
    ds_read_b64_tr_b16 v[134:135], v26 offset:1152
    s_waitcnt lgkmcnt(9)
    v_mfma_f32_32x32x16_bf16 v[32:47], v[104:107], v[72:75], v[32:47]
    ds_read_b128 v[120:123], v10 offset:0
    ds_read_b64_tr_b16 v[136:137], v26 offset:2048
    ds_read_b64_tr_b16 v[138:139], v26 offset:2176
    s_waitcnt lgkmcnt(9)
    v_mfma_f32_32x32x16_bf16 v[32:47], v[108:111], v[76:79], v[32:47]
    ds_read_b128 v[124:127], v11 offset:0
    ds_read_b64_tr_b16 v[140:141], v26 offset:3072
    ds_read_b64_tr_b16 v[142:143], v26 offset:3200
    s_waitcnt lgkmcnt(9)
    v_mfma_f32_16x16x32_bf16 v[4:7], v[128:131], v[112:115], 0
    s_waitcnt lgkmcnt(6)
    v_mfma_f32_16x16x32_bf16 v[4:7], v[132:135], v[116:119], v[4:7]
    s_waitcnt lgkmcnt(3)
    v_mfma_f32_16x16x32_bf16 v[4:7], v[136:139], v[120:123], v[4:7]
    s_waitcnt lgkmcnt(0)
    v_mfma_f32_16x16x32_bf16 v[4:7], v[140:143], v[124:127], v[4:7]
    s_barrier
    ds_read_b128 v[48:51], v16 offset:16384
    ds_read_b64_tr_b16 v[80:81], v24 offset:16384
    ds_read_b64_tr_b16 v[82:83], v24 offset:16896
    ds_read_b128 v[52:55], v17 offset:16384
    ds_read_b64_tr_b16 v[84:85], v24 offset:18432
    ds_read_b64_tr_b16 v[86:87], v24 offset:18944
    ds_read_b128 v[56:59], v18 offset:16384
    ds_read_b64_tr_b16 v[88:89], v24 offset:20480
    ds_read_b64_tr_b16 v[90:91], v24 offset:20992
    ds_read_b128 v[60:63], v19 offset:16384
    ds_read_b64_tr_b16 v[92:93], v24 offset:22528
    ds_read_b64_tr_b16 v[94:95], v24 offset:23040
    s_waitcnt lgkmcnt(9)
    v_mfma_f32_32x32x16_bf16 v[32:47], v[80:83], v[48:51], v[32:47]
    ds_read_b128 v[64:67], v20 offset:16384
    ds_read_b64_tr_b16 v[96:97], v24 offset:24576
    ds_read_b64_tr_b16 v[98:99], v24 offset:25088
    s_waitcnt lgkmcnt(9)
    v_mfma_f32_32x32x16_bf16 v[32:47], v[84:87], v[52:55], v[32:47]
    ds_read_b128 v[68:71], v21 offset:16384
    ds_read_b64_tr_b16 v[100:101], v24 offset:26624
    ds_read_b64_tr_b16 v[102:103], v24 offset:27136
    s_waitcnt lgkmcnt(9)
    v_mfma_f32_32x32x16_bf16 v[32:47], v[88:91], v[56:59], v[32:47]
    ds_read_b128 v[72:75], v22 offset:16384
    ds_read_b64_tr_b16 v[104:105], v24 offset:28672
    ds_read_b64_tr_b16 v[106:107], v24 offset:29184
    s_waitcnt lgkmcnt(9)
    v_mfma_f32_32x32x16_bf16 v[32:47], v[92:95], v[60:63], v[32:47]
    ds_read_b128 v[76:79], v23 offset:16384
    ds_read_b64_tr_b16 v[108:109], v24 offset:30720
    ds_read_b64_tr_b16 v[110:111], v24 offset:31232
    s_waitcnt lgkmcnt(9)
    v_mfma_f32_32x32x16_bf16 v[32:47], v[96:99], v[64:67], v[32:47]
    ds_read_b128 v[112:115], v8 offset:16384
    ds_read_b64_tr_b16 v[128:129], v26 offset:4096
    ds_read_b64_tr_b16 v[130:131], v26 offset:4224
    s_waitcnt lgkmcnt(9)
    v_mfma_f32_32x32x16_bf16 v[32:47], v[100:103], v[68:71], v[32:47]
    ds_read_b128 v[116:119], v9 offset:16384
    ds_read_b64_tr_b16 v[132:133], v26 offset:5120
    ds_read_b64_tr_b16 v[134:135], v26 offset:5248
    s_waitcnt lgkmcnt(9)
    v_mfma_f32_32x32x16_bf16 v[32:47], v[104:107], v[72:75], v[32:47]
    ds_read_b128 v[120:123], v10 offset:16384
    ds_read_b64_tr_b16 v[136:137], v26 offset:6144
    ds_read_b64_tr_b16 v[138:139], v26 offset:6272
    s_waitcnt lgkmcnt(9)
    v_mfma_f32_32x32x16_bf16 v[32:47], v[108:111], v[76:79], v[32:47]
    ds_read_b128 v[124:127], v11 offset:16384
    ds_read_b64_tr_b16 v[140:141], v26 offset:7168
    ds_read_b64_tr_b16 v[142:143], v26 offset:7296
    s_waitcnt lgkmcnt(9)
    v_mfma_f32_16x16x32_bf16 v[4:7], v[128:131], v[112:115], v[4:7]
    s_waitcnt lgkmcnt(6)
    v_mfma_f32_16x16x32_bf16 v[4:7], v[132:135], v[116:119], v[4:7]
    s_waitcnt lgkmcnt(3)
    v_mfma_f32_16x16x32_bf16 v[4:7], v[136:139], v[120:123], v[4:7]
    s_waitcnt lgkmcnt(0)
    v_mfma_f32_16x16x32_bf16 v[4:7], v[140:143], v[124:127], v[4:7]
    s_barrier
    ds_read_b128 v[48:51], v16 offset:32768
    ds_read_b64_tr_b16 v[80:81], v24 offset:32768
    ds_read_b64_tr_b16 v[82:83], v24 offset:33280
    ds_read_b128 v[52:55], v17 offset:32768
    ds_read_b64_tr_b16 v[84:85], v24 offset:34816
    ds_read_b64_tr_b16 v[86:87], v24 offset:35328
    ds_read_b128 v[56:59], v18 offset:32768
    ds_read_b64_tr_b16 v[88:89], v24 offset:36864
    ds_read_b64_tr_b16 v[90:91], v24 offset:37376
    ds_read_b128 v[60:63], v19 offset:32768
    ds_read_b64_tr_b16 v[92:93], v24 offset:38912
    ds_read_b64_tr_b16 v[94:95], v24 offset:39424
    s_waitcnt lgkmcnt(9)
    v_mfma_f32_32x32x16_bf16 v[32:47], v[80:83], v[48:51], v[32:47]
    ds_read_b128 v[64:67], v20 offset:32768
    ds_read_b64_tr_b16 v[96:97], v24 offset:40960
    ds_read_b64_tr_b16 v[98:99], v24 offset:41472
    s_waitcnt lgkmcnt(9)
    v_mfma_f32_32x32x16_bf16 v[32:47], v[84:87], v[52:55], v[32:47]
    ds_read_b128 v[68:71], v21 offset:32768
    ds_read_b64_tr_b16 v[100:101], v24 offset:43008
    ds_read_b64_tr_b16 v[102:103], v24 offset:43520
    s_waitcnt lgkmcnt(9)
    v_mfma_f32_32x32x16_bf16 v[32:47], v[88:91], v[56:59], v[32:47]
    ds_read_b128 v[72:75], v22 offset:32768
    ds_read_b64_tr_b16 v[104:105], v24 offset:45056
    ds_read_b64_tr_b16 v[106:107], v24 offset:45568
    s_waitcnt lgkmcnt(9)
    v_mfma_f32_32x32x16_bf16 v[32:47], v[92:95], v[60:63], v[32:47]
    ds_read_b128 v[76:79], v23 offset:32768
    ds_read_b64_tr_b16 v[108:109], v24 offset:47104
    ds_read_b64_tr_b16 v[110:111], v24 offset:47616
    s_waitcnt lgkmcnt(9)
    v_mfma_f32_32x32x16_bf16 v[32:47], v[96:99], v[64:67], v[32:47]
    ds_read_b128 v[112:115], v8 offset:32768
    ds_read_b64_tr_b16 v[128:129], v26 offset:8192
    ds_read_b64_tr_b16 v[130:131], v26 offset:8320
    s_waitcnt lgkmcnt(9)
    v_mfma_f32_32x32x16_bf16 v[32:47], v[100:103], v[68:71], v[32:47]
    ds_read_b128 v[116:119], v9 offset:32768
    ds_read_b64_tr_b16 v[132:133], v26 offset:9216
    ds_read_b64_tr_b16 v[134:135], v26 offset:9344
    s_waitcnt lgkmcnt(9)
    v_mfma_f32_32x32x16_bf16 v[32:47], v[104:107], v[72:75], v[32:47]
    ds_read_b128 v[120:123], v10 offset:32768
    ds_read_b64_tr_b16 v[136:137], v26 offset:10240
    ds_read_b64_tr_b16 v[138:139], v26 offset:10368
    s_waitcnt lgkmcnt(9)
    v_mfma_f32_32x32x16_bf16 v[32:47], v[108:111], v[76:79], v[32:47]
    ds_read_b128 v[124:127], v11 offset:32768
    ds_read_b64_tr_b16 v[140:141], v26 offset:11264
    ds_read_b64_tr_b16 v[142:143], v26 offset:11392
    s_waitcnt lgkmcnt(9)
    v_mfma_f32_16x16x32_bf16 v[4:7], v[128:131], v[112:115], v[4:7]
    s_waitcnt lgkmcnt(6)
    v_mfma_f32_16x16x32_bf16 v[4:7], v[132:135], v[116:119], v[4:7]
    s_waitcnt lgkmcnt(3)
    v_mfma_f32_16x16x32_bf16 v[4:7], v[136:139], v[120:123], v[4:7]
    s_waitcnt lgkmcnt(0)
    v_mfma_f32_16x16x32_bf16 v[4:7], v[140:143], v[124:127], v[4:7]
    s_barrier
    ds_read_b128 v[48:51], v16 offset:49152
    ds_read_b64_tr_b16 v[80:81], v24 offset:49152
    ds_read_b64_tr_b16 v[82:83], v24 offset:49664
    ds_read_b128 v[52:55], v17 offset:49152
    ds_read_b64_tr_b16 v[84:85], v24 offset:51200
    ds_read_b64_tr_b16 v[86:87], v24 offset:51712
    ds_read_b128 v[56:59], v18 offset:49152
    ds_read_b64_tr_b16 v[88:89], v24 offset:53248
    ds_read_b64_tr_b16 v[90:91], v24 offset:53760
    ds_read_b128 v[60:63], v19 offset:49152
    ds_read_b64_tr_b16 v[92:93], v24 offset:55296
    ds_read_b64_tr_b16 v[94:95], v24 offset:55808
    s_waitcnt lgkmcnt(9)
    v_mfma_f32_32x32x16_bf16 v[32:47], v[80:83], v[48:51], v[32:47]
    ds_read_b128 v[64:67], v20 offset:49152
    ds_read_b64_tr_b16 v[96:97], v24 offset:57344
    ds_read_b64_tr_b16 v[98:99], v24 offset:57856
    s_waitcnt lgkmcnt(9)
    v_mfma_f32_32x32x16_bf16 v[32:47], v[84:87], v[52:55], v[32:47]
    ds_read_b128 v[68:71], v21 offset:49152
    ds_read_b64_tr_b16 v[100:101], v24 offset:59392
    ds_read_b64_tr_b16 v[102:103], v24 offset:59904
    s_waitcnt lgkmcnt(9)
    v_mfma_f32_32x32x16_bf16 v[32:47], v[88:91], v[56:59], v[32:47]
    ds_read_b128 v[72:75], v22 offset:49152
    ds_read_b64_tr_b16 v[104:105], v24 offset:61440
    ds_read_b64_tr_b16 v[106:107], v24 offset:61952
    s_waitcnt lgkmcnt(9)
    v_mfma_f32_32x32x16_bf16 v[32:47], v[92:95], v[60:63], v[32:47]
    ds_read_b128 v[76:79], v23 offset:49152
    ds_read_b64_tr_b16 v[108:109], v24 offset:63488
    ds_read_b64_tr_b16 v[110:111], v24 offset:64000
    s_waitcnt lgkmcnt(9)
    v_mfma_f32_32x32x16_bf16 v[32:47], v[96:99], v[64:67], v[32:47]
    ds_read_b128 v[112:115], v8 offset:49152
    ds_read_b64_tr_b16 v[128:129], v26 offset:12288
    ds_read_b64_tr_b16 v[130:131], v26 offset:12416
    s_waitcnt lgkmcnt(9)
    v_mfma_f32_32x32x16_bf16 v[32:47], v[100:103], v[68:71], v[32:47]
    ds_read_b128 v[116:119], v9 offset:49152
    ds_read_b64_tr_b16 v[132:133], v26 offset:13312
    ds_read_b64_tr_b16 v[134:135], v26 offset:13440
    s_waitcnt lgkmcnt(9)
    v_mfma_f32_32x32x16_bf16 v[32:47], v[104:107], v[72:75], v[32:47]
    ds_read_b128 v[120:123], v10 offset:49152
    ds_read_b64_tr_b16 v[136:137], v26 offset:14336
    ds_read_b64_tr_b16 v[138:139], v26 offset:14464
    s_waitcnt lgkmcnt(9)
    v_mfma_f32_32x32x16_bf16 v[32:47], v[108:111], v[76:79], v[32:47]
    ds_read_b128 v[124:127], v11 offset:49152
    ds_read_b64_tr_b16 v[140:141], v26 offset:15360
    ds_read_b64_tr_b16 v[142:143], v26 offset:15488
    s_waitcnt lgkmcnt(9)
    v_mfma_f32_16x16x32_bf16 v[4:7], v[128:131], v[112:115], v[4:7]
    s_waitcnt lgkmcnt(6)
    v_mfma_f32_16x16x32_bf16 v[4:7], v[132:135], v[116:119], v[4:7]
    s_waitcnt lgkmcnt(3)
    v_mfma_f32_16x16x32_bf16 v[4:7], v[136:139], v[120:123], v[4:7]
    s_waitcnt lgkmcnt(0)
    v_mfma_f32_16x16x32_bf16 v[4:7], v[140:143], v[124:127], v[4:7]
    s_nop 3
    v_cvt_pk_bf16_f32 v48, v32, v33
    v_cvt_pk_bf16_f32 v49, v34, v35
    v_cvt_pk_bf16_f32 v50, v36, v37
    v_cvt_pk_bf16_f32 v51, v38, v39
    buffer_store_dwordx4 v[48:51], v25, s[32:35], s52 offen
    v_cvt_pk_bf16_f32 v52, v40, v41
    v_cvt_pk_bf16_f32 v53, v42, v43
    v_cvt_pk_bf16_f32 v54, v44, v45
    v_cvt_pk_bf16_f32 v55, v46, v47
    buffer_store_dwordx4 v[52:55], v25, s[32:35], s52 offen offset:128
    v_cvt_pk_bf16_f32 v112, v4, v5
    v_cvt_pk_bf16_f32 v113, v6, v7
    v_lshlrev_b32 v4, 16, v112
    v_and_b32 v5, 0xffff0000, v112
    v_lshlrev_b32 v6, 16, v113
    v_and_b32 v7, 0xffff0000, v113
    v_mul_f32 v4, 0x3eb8aa3b, v4
    v_mul_f32 v5, 0x3eb8aa3b, v5
    v_mul_f32 v6, 0x3eb8aa3b, v6
    v_mul_f32 v7, 0x3eb8aa3b, v7
    v_cvt_pk_bf16_f32 v112, v4, v5
    v_cvt_pk_bf16_f32 v113, v6, v7
    buffer_store_dwordx2 v[112:113], v14, s[32:35], s54 offen
    s_endpgm
K1_v:
    v_lshl_add_u32 v14, v13, 9, v14
    v_lshl_add_u32 v14, v12, 3, v14
    s_barrier
    ds_read_b128 v[48:51], v16 offset:0
    ds_read_b64_tr_b16 v[80:81], v24 offset:0
    ds_read_b64_tr_b16 v[82:83], v24 offset:512
    ds_read_b128 v[52:55], v17 offset:0
    ds_read_b64_tr_b16 v[84:85], v24 offset:2048
    ds_read_b64_tr_b16 v[86:87], v24 offset:2560
    ds_read_b128 v[56:59], v18 offset:0
    ds_read_b64_tr_b16 v[88:89], v24 offset:4096
    ds_read_b64_tr_b16 v[90:91], v24 offset:4608
    ds_read_b128 v[60:63], v19 offset:0
    ds_read_b64_tr_b16 v[92:93], v24 offset:6144
    ds_read_b64_tr_b16 v[94:95], v24 offset:6656
    s_waitcnt lgkmcnt(9)
    v_mfma_f32_32x32x16_bf16 v[32:47], v[80:83], v[48:51], 0
    ds_read_b128 v[64:67], v20 offset:0
    ds_read_b64_tr_b16 v[96:97], v24 offset:8192
    ds_read_b64_tr_b16 v[98:99], v24 offset:8704
    s_waitcnt lgkmcnt(9)
    v_mfma_f32_32x32x16_bf16 v[32:47], v[84:87], v[52:55], v[32:47]
    ds_read_b128 v[68:71], v21 offset:0
    ds_read_b64_tr_b16 v[100:101], v24 offset:10240
    ds_read_b64_tr_b16 v[102:103], v24 offset:10752
    s_waitcnt lgkmcnt(9)
    v_mfma_f32_32x32x16_bf16 v[32:47], v[88:91], v[56:59], v[32:47]
    ds_read_b128 v[72:75], v22 offset:0
    ds_read_b64_tr_b16 v[104:105], v24 offset:12288
    ds_read_b64_tr_b16 v[106:107], v24 offset:12800
    s_waitcnt lgkmcnt(9)
    v_mfma_f32_32x32x16_bf16 v[32:47], v[92:95], v[60:63], v[32:47]
    ds_read_b128 v[76:79], v23 offset:0
    ds_read_b64_tr_b16 v[108:109], v24 offset:14336
    ds_read_b64_tr_b16 v[110:111], v24 offset:14848
    s_waitcnt lgkmcnt(9)
    v_mfma_f32_32x32x16_bf16 v[32:47], v[96:99], v[64:67], v[32:47]
    ds_read_b128 v[112:115], v8 offset:0
    ds_read_b64_tr_b16 v[128:129], v26 offset:0
    ds_read_b64_tr_b16 v[130:131], v26 offset:128
    s_waitcnt lgkmcnt(9)
    v_mfma_f32_32x32x16_bf16 v[32:47], v[100:103], v[68:71], v[32:47]
    ds_read_b128 v[116:119], v9 offset:0
    ds_read_b64_tr_b16 v[132:133], v26 offset:1024
    ds_read_b64_tr_b16 v[134:135], v26 offset:1152
    s_waitcnt lgkmcnt(9)
    v_mfma_f32_32x32x16_bf16 v[32:47], v[104:107], v[72:75], v[32:47]
    ds_read_b128 v[120:123], v10 offset:0
    ds_read_b64_tr_b16 v[136:137], v26 offset:2048
    ds_read_b64_tr_b16 v[138:139], v26 offset:2176
    s_waitcnt lgkmcnt(9)
    v_mfma_f32_32x32x16_bf16 v[32:47], v[108:111], v[76:79], v[32:47]
    ds_read_b128 v[124:127], v11 offset:0
    ds_read_b64_tr_b16 v[140:141], v26 offset:3072
    ds_read_b64_tr_b16 v[142:143], v26 offset:3200
    s_waitcnt lgkmcnt(9)
    v_mfma_f32_16x16x32_bf16 v[4:7], v[112:115], v[128:131], 0
    s_waitcnt lgkmcnt(6)
    v_mfma_f32_16x16x32_bf16 v[4:7], v[116:119], v[132:135], v[4:7]
    s_waitcnt lgkmcnt(3)
    v_mfma_f32_16x16x32_bf16 v[4:7], v[120:123], v[136:139], v[4:7]
    s_waitcnt lgkmcnt(0)
    v_mfma_f32_16x16x32_bf16 v[4:7], v[124:127], v[140:143], v[4:7]
    s_barrier
    ds_read_b128 v[48:51], v16 offset:16384
    ds_read_b64_tr_b16 v[80:81], v24 offset:16384
    ds_read_b64_tr_b16 v[82:83], v24 offset:16896
    ds_read_b128 v[52:55], v17 offset:16384
    ds_read_b64_tr_b16 v[84:85], v24 offset:18432
    ds_read_b64_tr_b16 v[86:87], v24 offset:18944
    ds_read_b128 v[56:59], v18 offset:16384
    ds_read_b64_tr_b16 v[88:89], v24 offset:20480
    ds_read_b64_tr_b16 v[90:91], v24 offset:20992
    ds_read_b128 v[60:63], v19 offset:16384
    ds_read_b64_tr_b16 v[92:93], v24 offset:22528
    ds_read_b64_tr_b16 v[94:95], v24 offset:23040
    s_waitcnt lgkmcnt(9)
    v_mfma_f32_32x32x16_bf16 v[32:47], v[80:83], v[48:51], v[32:47]
    ds_read_b128 v[64:67], v20 offset:16384
    ds_read_b64_tr_b16 v[96:97], v24 offset:24576
    ds_read_b64_tr_b16 v[98:99], v24 offset:25088
    s_waitcnt lgkmcnt(9)
    v_mfma_f32_32x32x16_bf16 v[32:47], v[84:87], v[52:55], v[32:47]
    ds_read_b128 v[68:71], v21 offset:16384
    ds_read_b64_tr_b16 v[100:101], v24 offset:26624
    ds_read_b64_tr_b16 v[102:103], v24 offset:27136
    s_waitcnt lgkmcnt(9)
    v_mfma_f32_32x32x16_bf16 v[32:47], v[88:91], v[56:59], v[32:47]
    ds_read_b128 v[72:75], v22 offset:16384
    ds_read_b64_tr_b16 v[104:105], v24 offset:28672
    ds_read_b64_tr_b16 v[106:107], v24 offset:29184
    s_waitcnt lgkmcnt(9)
    v_mfma_f32_32x32x16_bf16 v[32:47], v[92:95], v[60:63], v[32:47]
    ds_read_b128 v[76:79], v23 offset:16384
    ds_read_b64_tr_b16 v[108:109], v24 offset:30720
    ds_read_b64_tr_b16 v[110:111], v24 offset:31232
    s_waitcnt lgkmcnt(9)
    v_mfma_f32_32x32x16_bf16 v[32:47], v[96:99], v[64:67], v[32:47]
    ds_read_b128 v[112:115], v8 offset:16384
    ds_read_b64_tr_b16 v[128:129], v26 offset:4096
    ds_read_b64_tr_b16 v[130:131], v26 offset:4224
    s_waitcnt lgkmcnt(9)
    v_mfma_f32_32x32x16_bf16 v[32:47], v[100:103], v[68:71], v[32:47]
    ds_read_b128 v[116:119], v9 offset:16384
    ds_read_b64_tr_b16 v[132:133], v26 offset:5120
    ds_read_b64_tr_b16 v[134:135], v26 offset:5248
    s_waitcnt lgkmcnt(9)
    v_mfma_f32_32x32x16_bf16 v[32:47], v[104:107], v[72:75], v[32:47]
    ds_read_b128 v[120:123], v10 offset:16384
    ds_read_b64_tr_b16 v[136:137], v26 offset:6144
    ds_read_b64_tr_b16 v[138:139], v26 offset:6272
    s_waitcnt lgkmcnt(9)
    v_mfma_f32_32x32x16_bf16 v[32:47], v[108:111], v[76:79], v[32:47]
    ds_read_b128 v[124:127], v11 offset:16384
    ds_read_b64_tr_b16 v[140:141], v26 offset:7168
    ds_read_b64_tr_b16 v[142:143], v26 offset:7296
    s_waitcnt lgkmcnt(9)
    v_mfma_f32_16x16x32_bf16 v[4:7], v[112:115], v[128:131], v[4:7]
    s_waitcnt lgkmcnt(6)
    v_mfma_f32_16x16x32_bf16 v[4:7], v[116:119], v[132:135], v[4:7]
    s_waitcnt lgkmcnt(3)
    v_mfma_f32_16x16x32_bf16 v[4:7], v[120:123], v[136:139], v[4:7]
    s_waitcnt lgkmcnt(0)
    v_mfma_f32_16x16x32_bf16 v[4:7], v[124:127], v[140:143], v[4:7]
    s_barrier
    ds_read_b128 v[48:51], v16 offset:32768
    ds_read_b64_tr_b16 v[80:81], v24 offset:32768
    ds_read_b64_tr_b16 v[82:83], v24 offset:33280
    ds_read_b128 v[52:55], v17 offset:32768
    ds_read_b64_tr_b16 v[84:85], v24 offset:34816
    ds_read_b64_tr_b16 v[86:87], v24 offset:35328
    ds_read_b128 v[56:59], v18 offset:32768
    ds_read_b64_tr_b16 v[88:89], v24 offset:36864
    ds_read_b64_tr_b16 v[90:91], v24 offset:37376
    ds_read_b128 v[60:63], v19 offset:32768
    ds_read_b64_tr_b16 v[92:93], v24 offset:38912
    ds_read_b64_tr_b16 v[94:95], v24 offset:39424
    s_waitcnt lgkmcnt(9)
    v_mfma_f32_32x32x16_bf16 v[32:47], v[80:83], v[48:51], v[32:47]
    ds_read_b128 v[64:67], v20 offset:32768
    ds_read_b64_tr_b16 v[96:97], v24 offset:40960
    ds_read_b64_tr_b16 v[98:99], v24 offset:41472
    s_waitcnt lgkmcnt(9)
    v_mfma_f32_32x32x16_bf16 v[32:47], v[84:87], v[52:55], v[32:47]
    ds_read_b128 v[68:71], v21 offset:32768
    ds_read_b64_tr_b16 v[100:101], v24 offset:43008
    ds_read_b64_tr_b16 v[102:103], v24 offset:43520
    s_waitcnt lgkmcnt(9)
    v_mfma_f32_32x32x16_bf16 v[32:47], v[88:91], v[56:59], v[32:47]
    ds_read_b128 v[72:75], v22 offset:32768
    ds_read_b64_tr_b16 v[104:105], v24 offset:45056
    ds_read_b64_tr_b16 v[106:107], v24 offset:45568
    s_waitcnt lgkmcnt(9)
    v_mfma_f32_32x32x16_bf16 v[32:47], v[92:95], v[60:63], v[32:47]
    ds_read_b128 v[76:79], v23 offset:32768
    ds_read_b64_tr_b16 v[108:109], v24 offset:47104
    ds_read_b64_tr_b16 v[110:111], v24 offset:47616
    s_waitcnt lgkmcnt(9)
    v_mfma_f32_32x32x16_bf16 v[32:47], v[96:99], v[64:67], v[32:47]
    ds_read_b128 v[112:115], v8 offset:32768
    ds_read_b64_tr_b16 v[128:129], v26 offset:8192
    ds_read_b64_tr_b16 v[130:131], v26 offset:8320
    s_waitcnt lgkmcnt(9)
    v_mfma_f32_32x32x16_bf16 v[32:47], v[100:103], v[68:71], v[32:47]
    ds_read_b128 v[116:119], v9 offset:32768
    ds_read_b64_tr_b16 v[132:133], v26 offset:9216
    ds_read_b64_tr_b16 v[134:135], v26 offset:9344
    s_waitcnt lgkmcnt(9)
    v_mfma_f32_32x32x16_bf16 v[32:47], v[104:107], v[72:75], v[32:47]
    ds_read_b128 v[120:123], v10 offset:32768
    ds_read_b64_tr_b16 v[136:137], v26 offset:10240
    ds_read_b64_tr_b16 v[138:139], v26 offset:10368
    s_waitcnt lgkmcnt(9)
    v_mfma_f32_32x32x16_bf16 v[32:47], v[108:111], v[76:79], v[32:47]
    ds_read_b128 v[124:127], v11 offset:32768
    ds_read_b64_tr_b16 v[140:141], v26 offset:11264
    ds_read_b64_tr_b16 v[142:143], v26 offset:11392
    s_waitcnt lgkmcnt(9)
    v_mfma_f32_16x16x32_bf16 v[4:7], v[112:115], v[128:131], v[4:7]
    s_waitcnt lgkmcnt(6)
    v_mfma_f32_16x16x32_bf16 v[4:7], v[116:119], v[132:135], v[4:7]
    s_waitcnt lgkmcnt(3)
    v_mfma_f32_16x16x32_bf16 v[4:7], v[120:123], v[136:139], v[4:7]
    s_waitcnt lgkmcnt(0)
    v_mfma_f32_16x16x32_bf16 v[4:7], v[124:127], v[140:143], v[4:7]
    s_barrier
    ds_read_b128 v[48:51], v16 offset:49152
    ds_read_b64_tr_b16 v[80:81], v24 offset:49152
    ds_read_b64_tr_b16 v[82:83], v24 offset:49664
    ds_read_b128 v[52:55], v17 offset:49152
    ds_read_b64_tr_b16 v[84:85], v24 offset:51200
    ds_read_b64_tr_b16 v[86:87], v24 offset:51712
    ds_read_b128 v[56:59], v18 offset:49152
    ds_read_b64_tr_b16 v[88:89], v24 offset:53248
    ds_read_b64_tr_b16 v[90:91], v24 offset:53760
    ds_read_b128 v[60:63], v19 offset:49152
    ds_read_b64_tr_b16 v[92:93], v24 offset:55296
    ds_read_b64_tr_b16 v[94:95], v24 offset:55808
    s_waitcnt lgkmcnt(9)
    v_mfma_f32_32x32x16_bf16 v[32:47], v[80:83], v[48:51], v[32:47]
    ds_read_b128 v[64:67], v20 offset:49152
    ds_read_b64_tr_b16 v[96:97], v24 offset:57344
    ds_read_b64_tr_b16 v[98:99], v24 offset:57856
    s_waitcnt lgkmcnt(9)
    v_mfma_f32_32x32x16_bf16 v[32:47], v[84:87], v[52:55], v[32:47]
    ds_read_b128 v[68:71], v21 offset:49152
    ds_read_b64_tr_b16 v[100:101], v24 offset:59392
    ds_read_b64_tr_b16 v[102:103], v24 offset:59904
    s_waitcnt lgkmcnt(9)
    v_mfma_f32_32x32x16_bf16 v[32:47], v[88:91], v[56:59], v[32:47]
    ds_read_b128 v[72:75], v22 offset:49152
    ds_read_b64_tr_b16 v[104:105], v24 offset:61440
    ds_read_b64_tr_b16 v[106:107], v24 offset:61952
    s_waitcnt lgkmcnt(9)
    v_mfma_f32_32x32x16_bf16 v[32:47], v[92:95], v[60:63], v[32:47]
    ds_read_b128 v[76:79], v23 offset:49152
    ds_read_b64_tr_b16 v[108:109], v24 offset:63488
    ds_read_b64_tr_b16 v[110:111], v24 offset:64000
    s_waitcnt lgkmcnt(9)
    v_mfma_f32_32x32x16_bf16 v[32:47], v[96:99], v[64:67], v[32:47]
    ds_read_b128 v[112:115], v8 offset:49152
    ds_read_b64_tr_b16 v[128:129], v26 offset:12288
    ds_read_b64_tr_b16 v[130:131], v26 offset:12416
    s_waitcnt lgkmcnt(9)
    v_mfma_f32_32x32x16_bf16 v[32:47], v[100:103], v[68:71], v[32:47]
    ds_read_b128 v[116:119], v9 offset:49152
    ds_read_b64_tr_b16 v[132:133], v26 offset:13312
    ds_read_b64_tr_b16 v[134:135], v26 offset:13440
    s_waitcnt lgkmcnt(9)
    v_mfma_f32_32x32x16_bf16 v[32:47], v[104:107], v[72:75], v[32:47]
    ds_read_b128 v[120:123], v10 offset:49152
    ds_read_b64_tr_b16 v[136:137], v26 offset:14336
    ds_read_b64_tr_b16 v[138:139], v26 offset:14464
    s_waitcnt lgkmcnt(9)
    v_mfma_f32_32x32x16_bf16 v[32:47], v[108:111], v[76:79], v[32:47]
    ds_read_b128 v[124:127], v11 offset:49152
    ds_read_b64_tr_b16 v[140:141], v26 offset:15360
    ds_read_b64_tr_b16 v[142:143], v26 offset:15488
    s_waitcnt lgkmcnt(9)
    v_mfma_f32_16x16x32_bf16 v[4:7], v[112:115], v[128:131], v[4:7]
    s_waitcnt lgkmcnt(6)
    v_mfma_f32_16x16x32_bf16 v[4:7], v[116:119], v[132:135], v[4:7]
    s_waitcnt lgkmcnt(3)
    v_mfma_f32_16x16x32_bf16 v[4:7], v[120:123], v[136:139], v[4:7]
    s_waitcnt lgkmcnt(0)
    v_mfma_f32_16x16x32_bf16 v[4:7], v[124:127], v[140:143], v[4:7]
    s_nop 3
    v_cvt_pk_bf16_f32 v48, v32, v33
    v_cvt_pk_bf16_f32 v49, v34, v35
    v_cvt_pk_bf16_f32 v50, v36, v37
    v_cvt_pk_bf16_f32 v51, v38, v39
    buffer_store_dwordx4 v[48:51], v25, s[32:35], s52 offen
    v_cvt_pk_bf16_f32 v52, v40, v41
    v_cvt_pk_bf16_f32 v53, v42, v43
    v_cvt_pk_bf16_f32 v54, v44, v45
    v_cvt_pk_bf16_f32 v55, v46, v47
    buffer_store_dwordx4 v[52:55], v25, s[32:35], s52 offen offset:128
    v_cvt_pk_bf16_f32 v112, v4, v5
    v_cvt_pk_bf16_f32 v113, v6, v7
    buffer_store_dwordx2 v[112:113], v14, s[32:35], s54 offen offset:1024
    s_endpgm
K1_rg:
    v_cmp_eq_u32 vcc, 1, v3
    v_lshlrev_b32 v26, 4, v2
    v_add_u32 v26, 131072, v26
    v_add_u32 v27, 1024, v26
    v_cndmask_b32 v26, v26, v27, vcc
    s_lshl_b32 s50, s42, 6
    s_lshl_b32 s51, s44, 4
    s_add_u32 s50, s50, s51
    s_sub_u32 s51, 2047, s50
    v_sub_u32 v30, s51, v0
    v_lshlrev_b32 v31, 2, v0
    s_lshl_b32 s51, s50, 2
    s_add_u32 s51, s51, 2752512
    s_lshr_b32 s50, s50, 2
    s_add_u32 s50, s50, 2760644
    s_barrier
    ds_read_b128 v[48:51], v16 offset:0
    ds_read_b64_tr_b16 v[80:81], v24 offset:0
    ds_read_b64_tr_b16 v[82:83], v24 offset:512
    ds_read_b128 v[52:55], v17 offset:0
    ds_read_b64_tr_b16 v[84:85], v24 offset:2048
    ds_read_b64_tr_b16 v[86:87], v24 offset:2560
    ds_read_b128 v[56:59], v18 offset:0
    ds_read_b64_tr_b16 v[88:89], v24 offset:4096
    ds_read_b64_tr_b16 v[90:91], v24 offset:4608
    ds_read_b128 v[60:63], v19 offset:0
    ds_read_b64_tr_b16 v[92:93], v24 offset:6144
    ds_read_b64_tr_b16 v[94:95], v24 offset:6656
    s_waitcnt lgkmcnt(9)
    v_mfma_f32_32x32x16_bf16 v[32:47], v[80:83], v[48:51], 0
    ds_read_b128 v[64:67], v20 offset:0
    ds_read_b64_tr_b16 v[96:97], v24 offset:8192
    ds_read_b64_tr_b16 v[98:99], v24 offset:8704
    s_waitcnt lgkmcnt(9)
    v_mfma_f32_32x32x16_bf16 v[32:47], v[84:87], v[52:55], v[32:47]
    ds_read_b128 v[68:71], v21 offset:0
    ds_read_b64_tr_b16 v[100:101], v24 offset:10240
    ds_read_b64_tr_b16 v[102:103], v24 offset:10752
    s_waitcnt lgkmcnt(9)
    v_mfma_f32_32x32x16_bf16 v[32:47], v[88:91], v[56:59], v[32:47]
    ds_read_b128 v[72:75], v22 offset:0
    ds_read_b64_tr_b16 v[104:105], v24 offset:12288
    ds_read_b64_tr_b16 v[106:107], v24 offset:12800
    s_waitcnt lgkmcnt(9)
    v_mfma_f32_32x32x16_bf16 v[32:47], v[92:95], v[60:63], v[32:47]
    ds_read_b128 v[76:79], v23 offset:0
    ds_read_b64_tr_b16 v[108:109], v24 offset:14336
    ds_read_b64_tr_b16 v[110:111], v24 offset:14848
    s_waitcnt lgkmcnt(9)
    v_mfma_f32_32x32x16_bf16 v[32:47], v[96:99], v[64:67], v[32:47]
    ds_read_b128 v[112:115], v8 offset:0
    ds_read_b128 v[128:131], v26 offset:0
    s_waitcnt lgkmcnt(8)
    v_mfma_f32_32x32x16_bf16 v[32:47], v[100:103], v[68:71], v[32:47]
    ds_read_b128 v[116:119], v9 offset:0
    ds_read_b128 v[132:135], v26 offset:64
    s_waitcnt lgkmcnt(7)
    v_mfma_f32_32x32x16_bf16 v[32:47], v[104:107], v[72:75], v[32:47]
    ds_read_b128 v[120:123], v10 offset:0
    ds_read_b128 v[136:139], v26 offset:128
    s_waitcnt lgkmcnt(6)
    v_mfma_f32_32x32x16_bf16 v[32:47], v[108:111], v[76:79], v[32:47]
    ds_read_b128 v[124:127], v11 offset:0
    ds_read_b128 v[140:143], v26 offset:192
    s_waitcnt lgkmcnt(6)
    v_mfma_f32_16x16x32_bf16 v[4:7], v[128:131], v[112:115], 0
    s_waitcnt lgkmcnt(4)
    v_mfma_f32_16x16x32_bf16 v[4:7], v[132:135], v[116:119], v[4:7]
    s_waitcnt lgkmcnt(2)
    v_mfma_f32_16x16x32_bf16 v[4:7], v[136:139], v[120:123], v[4:7]
    s_waitcnt lgkmcnt(0)
    v_mfma_f32_16x16x32_bf16 v[4:7], v[140:143], v[124:127], v[4:7]
    s_barrier
    ds_read_b128 v[48:51], v16 offset:16384
    ds_read_b64_tr_b16 v[80:81], v24 offset:16384
    ds_read_b64_tr_b16 v[82:83], v24 offset:16896
    ds_read_b128 v[52:55], v17 offset:16384
    ds_read_b64_tr_b16 v[84:85], v24 offset:18432
    ds_read_b64_tr_b16 v[86:87], v24 offset:18944
    ds_read_b128 v[56:59], v18 offset:16384
    ds_read_b64_tr_b16 v[88:89], v24 offset:20480
    ds_read_b64_tr_b16 v[90:91], v24 offset:20992
    ds_read_b128 v[60:63], v19 offset:16384
    ds_read_b64_tr_b16 v[92:93], v24 offset:22528
    ds_read_b64_tr_b16 v[94:95], v24 offset:23040
    s_waitcnt lgkmcnt(9)
    v_mfma_f32_32x32x16_bf16 v[32:47], v[80:83], v[48:51], v[32:47]
    ds_read_b128 v[64:67], v20 offset:16384
    ds_read_b64_tr_b16 v[96:97], v24 offset:24576
    ds_read_b64_tr_b16 v[98:99], v24 offset:25088
    s_waitcnt lgkmcnt(9)
    v_mfma_f32_32x32x16_bf16 v[32:47], v[84:87], v[52:55], v[32:47]
    ds_read_b128 v[68:71], v21 offset:16384
    ds_read_b64_tr_b16 v[100:101], v24 offset:26624
    ds_read_b64_tr_b16 v[102:103], v24 offset:27136
    s_waitcnt lgkmcnt(9)
    v_mfma_f32_32x32x16_bf16 v[32:47], v[88:91], v[56:59], v[32:47]
    ds_read_b128 v[72:75], v22 offset:16384
    ds_read_b64_tr_b16 v[104:105], v24 offset:28672
    ds_read_b64_tr_b16 v[106:107], v24 offset:29184
    s_waitcnt lgkmcnt(9)
    v_mfma_f32_32x32x16_bf16 v[32:47], v[92:95], v[60:63], v[32:47]
    ds_read_b128 v[76:79], v23 offset:16384
    ds_read_b64_tr_b16 v[108:109], v24 offset:30720
    ds_read_b64_tr_b16 v[110:111], v24 offset:31232
    s_waitcnt lgkmcnt(9)
    v_mfma_f32_32x32x16_bf16 v[32:47], v[96:99], v[64:67], v[32:47]
    ds_read_b128 v[112:115], v8 offset:16384
    ds_read_b128 v[128:131], v26 offset:256
    s_waitcnt lgkmcnt(8)
    v_mfma_f32_32x32x16_bf16 v[32:47], v[100:103], v[68:71], v[32:47]
    ds_read_b128 v[116:119], v9 offset:16384
    ds_read_b128 v[132:135], v26 offset:320
    s_waitcnt lgkmcnt(7)
    v_mfma_f32_32x32x16_bf16 v[32:47], v[104:107], v[72:75], v[32:47]
    ds_read_b128 v[120:123], v10 offset:16384
    ds_read_b128 v[136:139], v26 offset:384
    s_waitcnt lgkmcnt(6)
    v_mfma_f32_32x32x16_bf16 v[32:47], v[108:111], v[76:79], v[32:47]
    ds_read_b128 v[124:127], v11 offset:16384
    ds_read_b128 v[140:143], v26 offset:448
    s_waitcnt lgkmcnt(6)
    v_mfma_f32_16x16x32_bf16 v[4:7], v[128:131], v[112:115], v[4:7]
    s_waitcnt lgkmcnt(4)
    v_mfma_f32_16x16x32_bf16 v[4:7], v[132:135], v[116:119], v[4:7]
    s_waitcnt lgkmcnt(2)
    v_mfma_f32_16x16x32_bf16 v[4:7], v[136:139], v[120:123], v[4:7]
    s_waitcnt lgkmcnt(0)
    v_mfma_f32_16x16x32_bf16 v[4:7], v[140:143], v[124:127], v[4:7]
    s_barrier
    ds_read_b128 v[48:51], v16 offset:32768
    ds_read_b64_tr_b16 v[80:81], v24 offset:32768
    ds_read_b64_tr_b16 v[82:83], v24 offset:33280
    ds_read_b128 v[52:55], v17 offset:32768
    ds_read_b64_tr_b16 v[84:85], v24 offset:34816
    ds_read_b64_tr_b16 v[86:87], v24 offset:35328
    ds_read_b128 v[56:59], v18 offset:32768
    ds_read_b64_tr_b16 v[88:89], v24 offset:36864
    ds_read_b64_tr_b16 v[90:91], v24 offset:37376
    ds_read_b128 v[60:63], v19 offset:32768
    ds_read_b64_tr_b16 v[92:93], v24 offset:38912
    ds_read_b64_tr_b16 v[94:95], v24 offset:39424
    s_waitcnt lgkmcnt(9)
    v_mfma_f32_32x32x16_bf16 v[32:47], v[80:83], v[48:51], v[32:47]
    ds_read_b128 v[64:67], v20 offset:32768
    ds_read_b64_tr_b16 v[96:97], v24 offset:40960
    ds_read_b64_tr_b16 v[98:99], v24 offset:41472
    s_waitcnt lgkmcnt(9)
    v_mfma_f32_32x32x16_bf16 v[32:47], v[84:87], v[52:55], v[32:47]
    ds_read_b128 v[68:71], v21 offset:32768
    ds_read_b64_tr_b16 v[100:101], v24 offset:43008
    ds_read_b64_tr_b16 v[102:103], v24 offset:43520
    s_waitcnt lgkmcnt(9)
    v_mfma_f32_32x32x16_bf16 v[32:47], v[88:91], v[56:59], v[32:47]
    ds_read_b128 v[72:75], v22 offset:32768
    ds_read_b64_tr_b16 v[104:105], v24 offset:45056
    ds_read_b64_tr_b16 v[106:107], v24 offset:45568
    s_waitcnt lgkmcnt(9)
    v_mfma_f32_32x32x16_bf16 v[32:47], v[92:95], v[60:63], v[32:47]
    ds_read_b128 v[76:79], v23 offset:32768
    ds_read_b64_tr_b16 v[108:109], v24 offset:47104
    ds_read_b64_tr_b16 v[110:111], v24 offset:47616
    s_waitcnt lgkmcnt(9)
    v_mfma_f32_32x32x16_bf16 v[32:47], v[96:99], v[64:67], v[32:47]
    ds_read_b128 v[112:115], v8 offset:32768
    ds_read_b128 v[128:131], v26 offset:512
    s_waitcnt lgkmcnt(8)
    v_mfma_f32_32x32x16_bf16 v[32:47], v[100:103], v[68:71], v[32:47]
    ds_read_b128 v[116:119], v9 offset:32768
    ds_read_b128 v[132:135], v26 offset:576
    s_waitcnt lgkmcnt(7)
    v_mfma_f32_32x32x16_bf16 v[32:47], v[104:107], v[72:75], v[32:47]
    ds_read_b128 v[120:123], v10 offset:32768
    ds_read_b128 v[136:139], v26 offset:640
    s_waitcnt lgkmcnt(6)
    v_mfma_f32_32x32x16_bf16 v[32:47], v[108:111], v[76:79], v[32:47]
    ds_read_b128 v[124:127], v11 offset:32768
    ds_read_b128 v[140:143], v26 offset:704
    s_waitcnt lgkmcnt(6)
    v_mfma_f32_16x16x32_bf16 v[4:7], v[128:131], v[112:115], v[4:7]
    s_waitcnt lgkmcnt(4)
    v_mfma_f32_16x16x32_bf16 v[4:7], v[132:135], v[116:119], v[4:7]
    s_waitcnt lgkmcnt(2)
    v_mfma_f32_16x16x32_bf16 v[4:7], v[136:139], v[120:123], v[4:7]
    s_waitcnt lgkmcnt(0)
    v_mfma_f32_16x16x32_bf16 v[4:7], v[140:143], v[124:127], v[4:7]
    s_barrier
    ds_read_b128 v[48:51], v16 offset:49152
    ds_read_b64_tr_b16 v[80:81], v24 offset:49152
    ds_read_b64_tr_b16 v[82:83], v24 offset:49664
    ds_read_b128 v[52:55], v17 offset:49152
    ds_read_b64_tr_b16 v[84:85], v24 offset:51200
    ds_read_b64_tr_b16 v[86:87], v24 offset:51712
    ds_read_b128 v[56:59], v18 offset:49152
    ds_read_b64_tr_b16 v[88:89], v24 offset:53248
    ds_read_b64_tr_b16 v[90:91], v24 offset:53760
    ds_read_b128 v[60:63], v19 offset:49152
    ds_read_b64_tr_b16 v[92:93], v24 offset:55296
    ds_read_b64_tr_b16 v[94:95], v24 offset:55808
    s_waitcnt lgkmcnt(9)
    v_mfma_f32_32x32x16_bf16 v[32:47], v[80:83], v[48:51], v[32:47]
    ds_read_b128 v[64:67], v20 offset:49152
    ds_read_b64_tr_b16 v[96:97], v24 offset:57344
    ds_read_b64_tr_b16 v[98:99], v24 offset:57856
    s_waitcnt lgkmcnt(9)
    v_mfma_f32_32x32x16_bf16 v[32:47], v[84:87], v[52:55], v[32:47]
    ds_read_b128 v[68:71], v21 offset:49152
    ds_read_b64_tr_b16 v[100:101], v24 offset:59392
    ds_read_b64_tr_b16 v[102:103], v24 offset:59904
    s_waitcnt lgkmcnt(9)
    v_mfma_f32_32x32x16_bf16 v[32:47], v[88:91], v[56:59], v[32:47]
    ds_read_b128 v[72:75], v22 offset:49152
    ds_read_b64_tr_b16 v[104:105], v24 offset:61440
    ds_read_b64_tr_b16 v[106:107], v24 offset:61952
    s_waitcnt lgkmcnt(9)
    v_mfma_f32_32x32x16_bf16 v[32:47], v[92:95], v[60:63], v[32:47]
    ds_read_b128 v[76:79], v23 offset:49152
    ds_read_b64_tr_b16 v[108:109], v24 offset:63488
    ds_read_b64_tr_b16 v[110:111], v24 offset:64000
    s_waitcnt lgkmcnt(9)
    v_mfma_f32_32x32x16_bf16 v[32:47], v[96:99], v[64:67], v[32:47]
    ds_read_b128 v[112:115], v8 offset:49152
    ds_read_b128 v[128:131], v26 offset:768
    s_waitcnt lgkmcnt(8)
    v_mfma_f32_32x32x16_bf16 v[32:47], v[100:103], v[68:71], v[32:47]
    ds_read_b128 v[116:119], v9 offset:49152
    ds_read_b128 v[132:135], v26 offset:832
    s_waitcnt lgkmcnt(7)
    v_mfma_f32_32x32x16_bf16 v[32:47], v[104:107], v[72:75], v[32:47]
    ds_read_b128 v[120:123], v10 offset:49152
    ds_read_b128 v[136:139], v26 offset:896
    s_waitcnt lgkmcnt(6)
    v_mfma_f32_32x32x16_bf16 v[32:47], v[108:111], v[76:79], v[32:47]
    ds_read_b128 v[124:127], v11 offset:49152
    ds_read_b128 v[140:143], v26 offset:960
    s_waitcnt lgkmcnt(6)
    v_mfma_f32_16x16x32_bf16 v[4:7], v[128:131], v[112:115], v[4:7]
    s_waitcnt lgkmcnt(4)
    v_mfma_f32_16x16x32_bf16 v[4:7], v[132:135], v[116:119], v[4:7]
    s_waitcnt lgkmcnt(2)
    v_mfma_f32_16x16x32_bf16 v[4:7], v[136:139], v[120:123], v[4:7]
    s_waitcnt lgkmcnt(0)
    v_mfma_f32_16x16x32_bf16 v[4:7], v[140:143], v[124:127], v[4:7]
    s_nop 3
    v_cvt_pk_bf16_f32 v48, v32, v33
    v_cvt_pk_bf16_f32 v49, v34, v35
    v_cvt_pk_bf16_f32 v50, v36, v37
    v_cvt_pk_bf16_f32 v51, v38, v39
    buffer_store_dwordx4 v[48:51], v25, s[32:35], s52 offen
    v_cvt_pk_bf16_f32 v52, v40, v41
    v_cvt_pk_bf16_f32 v53, v42, v43
    v_cvt_pk_bf16_f32 v54, v44, v45
    v_cvt_pk_bf16_f32 v55, v46, v47
    buffer_store_dwordx4 v[52:55], v25, s[32:35], s52 offen offset:128
    v_cvt_pk_bf16_f32 v112, v5, v5
    v_and_b32 v113, 0xffff0000, v112
    v_mul_f32 v113, 0xbfb8aa3b, v113
    v_exp_f32 v113, v113
    v_ashrrev_i32 v115, 31, v4
    v_add_f32 v113, 1.0, v113
    v_rcp_f32 v113, v113
    v_or_b32 v115, 0x80000000, v115
    v_xor_b32 v114, v4, v115
    v_and_b32 v114, 0xfffff800, v114
    v_or_b32 v114, v114, v30
    v_cvt_pk_bf16_f32 v113, v113, v113
    v_and_b32 v113, 0xffff0000, v113
    v_max_u32_dpp v114, v114, v114 row_shr:1 row_mask:0xf bank_mask:0xf
    s_nop 1
    v_max_u32_dpp v114, v114, v114 row_shr:2 row_mask:0xf bank_mask:0xf
    s_nop 1
    v_max_u32_dpp v114, v114, v114 row_shr:4 row_mask:0xf bank_mask:0xf
    s_nop 1
    v_max_u32_dpp v114, v114, v114 row_shr:8 row_mask:0xf bank_mask:0xf
    s_nop 1
    s_mov_b64 exec, 0xffff
    buffer_store_dword v113, v31, s[32:35], s51 offen
    s_mov_b64 exec, 0x8000
    buffer_store_dword v114, v31, s[32:35], s50 offen
    s_mov_b64 exec, -1
    s_endpgm
.globl attn_kernel
.p2align 8
.type attn_kernel,@function
attn_kernel:
    s_cmp_ge_u32 s2, 256
    s_cbranch_scc1 K2_exit
    s_load_dwordx2 s[12:13], s[0:1], 104
    s_load_dwordx2 s[8:9], s[0:1], 0
    s_load_dwordx2 s[16:17], s[0:1], 88
    v_lshrrev_b32 v12, 6, v0
    v_and_b32 v0, 63, v0
    v_readfirstlane_b32 s40, v12
    s_mov_b32 s14, 2842624
    s_mov_b32 s15, 0x20000
    v_lshlrev_b32 v1, 4, v0
    s_and_b32 s50, s2, 7
    s_lshr_b32 s51, s2, 3
    s_lshl_b32 s41, s50, 5
    s_add_u32 s41, s41, s51
    s_and_b32 s49, s51, 7
    s_and_b32 s46, s40, 3
    s_lshl_b32 s43, s41, 13
    s_mov_b32 s44, 0
    s_cmp_ge_u32 s40, 4
    s_cbranch_scc1 K2_service
    s_lshl2_add_u32 s61, s50, s46
    s_lshl_b32 s61, s61, 12
    s_lshl_b32 s52, s49, 10
    s_add_u32 s52, s52, s43
    s_add_u32 s53, s61, 2097152
    s_mul_i32 s54, s46, 20480
    s_mov_b32 m0, s54
    v_mov_b32 v3, 0
    v_mov_b32 v5, 0xdddd
    s_setprio 1
    v_and_b32 v14, 11, v0
    v_cmp_eq_u32 vcc, 0, v14
    v_mov_b32 v13, 0x3f803f80
    v_mov_b64 v[6:7], 0
    v_cndmask_b32 v14, 0, v13, vcc
    v_cndmask_b32 v15, 0, v13, vcc
    v_mfma_f32_32x32x8_bf16 v[16:31], v[6:7], v[6:7], 0
    v_mov_b64 v[132:133], v[14:15]
    v_mov_b64 v[134:135], v[14:15]
    v_mov_b64 v[140:141], v[14:15]
    v_mov_b64 v[142:143], v[14:15]
    v_mov_b64 v[148:149], v[14:15]
    v_mov_b64 v[150:151], v[14:15]
    v_mov_b64 v[156:157], v[14:15]
    v_mov_b64 v[158:159], v[14:15]
    v_mov_b64 v[164:165], v[14:15]
    v_mov_b64 v[166:167], v[14:15]
    v_mov_b64 v[172:173], v[14:15]
    v_mov_b64 v[174:175], v[14:15]
    v_mov_b64 v[180:181], v[14:15]
    v_mov_b64 v[182:183], v[14:15]
    v_mov_b64 v[188:189], v[14:15]
    v_mov_b64 v[190:191], v[14:15]
    v_mov_b64 v[196:197], v[14:15]
    v_mov_b64 v[198:199], v[14:15]
    v_mov_b64 v[204:205], v[14:15]
    v_mov_b64 v[206:207], v[14:15]
    v_mov_b64 v[212:213], v[14:15]
    v_mov_b64 v[214:215], v[14:15]
    v_mov_b64 v[220:221], v[14:15]
    v_mov_b64 v[222:223], v[14:15]
    v_mov_b64 v[228:229], v[14:15]
    v_mov_b64 v[230:231], v[14:15]
    v_mov_b64 v[236:237], v[14:15]
    v_mov_b64 v[238:239], v[14:15]
    v_mov_b64 v[244:245], v[14:15]
    v_mov_b64 v[246:247], v[14:15]
    v_mov_b64 v[252:253], v[14:15]
    v_mov_b64 v[254:255], v[14:15]
    s_waitcnt lgkmcnt(0)
    buffer_load_dwordx4 v[8:11], v1, s[12:15], s52 offen
    buffer_load_dwordx4 v[64:67], v1, s[12:15], s53 offen offset:0
    buffer_load_dwordx4 v[128:131], v1, s[12:15], s53 offen offset:1024
    buffer_load_dwordx4 v[68:71], v1, s[12:15], s53 offen offset:2048
    buffer_load_dwordx4 v[136:139], v1, s[12:15], s53 offen offset:3072
    s_mul_i32 s55, s51, 37
    s_lshr_b32 s55, s55, 8
    s_mul_i32 s55, s55, 7
    s_sub_u32 s55, s51, s55
    s_add_u32 s55, s55, 1
    s_lshl_b32 s56, s55, 14
    s_add_u32 s56, s56, s61
    s_and_b32 s56, s56, 0x1ffff
    s_add_u32 s33, s56, 2097152
    s_cmp_eq_u32 s55, 7
    s_cselect_b32 s55, 0, s55
    buffer_load_dwordx4 v[72:75], v1, s[12:15], s33 offen offset:0
    buffer_load_dwordx4 v[144:147], v1, s[12:15], s33 offen offset:1024
    buffer_load_dwordx4 v[76:79], v1, s[12:15], s33 offen offset:2048
    buffer_load_dwordx4 v[152:155], v1, s[12:15], s33 offen offset:3072
    s_add_u32 s55, s55, 1
    s_lshl_b32 s56, s55, 14
    s_add_u32 s56, s56, s61
    s_and_b32 s56, s56, 0x1ffff
    s_add_u32 s34, s56, 2097152
    s_cmp_eq_u32 s55, 7
    s_cselect_b32 s55, 0, s55
    buffer_load_dwordx4 v[80:83], v1, s[12:15], s34 offen offset:0
    buffer_load_dwordx4 v[160:163], v1, s[12:15], s34 offen offset:1024
    buffer_load_dwordx4 v[84:87], v1, s[12:15], s34 offen offset:2048
    buffer_load_dwordx4 v[168:171], v1, s[12:15], s34 offen offset:3072
    s_add_u32 s55, s55, 1
    s_lshl_b32 s56, s55, 14
    s_add_u32 s56, s56, s61
    s_and_b32 s56, s56, 0x1ffff
    s_add_u32 s35, s56, 2097152
    s_cmp_eq_u32 s55, 7
    s_cselect_b32 s55, 0, s55
    s_add_u32 s55, s55, 1
    s_lshl_b32 s56, s55, 14
    s_add_u32 s56, s56, s61
    s_and_b32 s56, s56, 0x1ffff
    s_add_u32 s36, s56, 2097152
    s_cmp_eq_u32 s55, 7
    s_cselect_b32 s55, 0, s55
    s_add_u32 s55, s55, 1
    s_lshl_b32 s56, s55, 14
    s_add_u32 s56, s56, s61
    s_and_b32 s56, s56, 0x1ffff
    s_add_u32 s37, s56, 2097152
    s_cmp_eq_u32 s55, 7
    s_cselect_b32 s55, 0, s55
    s_add_u32 s55, s55, 1
    s_lshl_b32 s56, s55, 14
    s_add_u32 s56, s56, s61
    s_and_b32 s56, s56, 0x1ffff
    s_add_u32 s38, s56, 2097152
    s_cmp_eq_u32 s55, 7
    s_cselect_b32 s55, 0, s55
    s_add_u32 s55, s55, 1
    s_lshl_b32 s56, s55, 14
    s_add_u32 s56, s56, s61
    s_and_b32 s56, s56, 0x1ffff
    s_add_u32 s39, s56, 2097152
    s_cmp_eq_u32 s55, 7
    s_cselect_b32 s55, 0, s55
    s_mov_b32 s10, 2097152
    s_mov_b32 s11, 0x20000
    s_mov_b32 s18, 2097152
    s_mov_b32 s19, 0x20000
    s_waitcnt vmcnt(11)
    v_mfma_f32_32x32x16_bf16 v[32:47], v[64:67], v[8:11], 0
    s_nop 11
    v_exp_f32 v32, v32
    v_exp_f32 v33, v33
    v_exp_f32 v34, v34
    v_exp_f32 v35, v35
    v_exp_f32 v36, v36
    s_waitcnt vmcnt(9)
    v_mfma_f32_32x32x16_bf16 v[48:63], v[68:71], v[8:11], 0
    v_permlane16_swap_b32 v128, v132
    v_permlane16_swap_b32 v129, v133
    v_permlane16_swap_b32 v130, v134
    v_permlane16_swap_b32 v131, v135
    v_exp_f32 v37, v37
    v_exp_f32 v38, v38
    v_exp_f32 v39, v39
    v_exp_f32 v40, v40
    v_exp_f32 v41, v41
    v_smfmac_f32_32x32x32_bf16 v[16:31], v[128:131], v[32:39], v5
    v_exp_f32 v42, v42
    v_exp_f32 v43, v43
    v_exp_f32 v44, v44
    buffer_load_dwordx4 v[88:91], v1, s[12:15], s35 offen offset:0
    buffer_load_dwordx4 v[176:179], v1, s[12:15], s35 offen offset:1024
    v_exp_f32 v45, v45
    v_exp_f32 v46, v46
    v_exp_f32 v47, v47
    v_exp_f32 v48, v48
    v_exp_f32 v49, v49
    v_smfmac_f32_32x32x32_bf16 v[16:31], v[132:135], v[40:47], v5
    v_exp_f32 v50, v50
    v_exp_f32 v51, v51
    v_exp_f32 v52, v52
    s_waitcnt vmcnt(9)
    v_mfma_f32_32x32x16_bf16 v[32:47], v[72:75], v[8:11], 0
    v_permlane16_swap_b32 v136, v140
    v_permlane16_swap_b32 v137, v141
    v_permlane16_swap_b32 v138, v142
    v_permlane16_swap_b32 v139, v143
    v_exp_f32 v53, v53
    v_exp_f32 v54, v54
    v_exp_f32 v55, v55
    v_exp_f32 v56, v56
    v_exp_f32 v57, v57
    v_smfmac_f32_32x32x32_bf16 v[16:31], v[136:139], v[48:55], v5
    v_exp_f32 v58, v58
    v_exp_f32 v59, v59
    v_exp_f32 v60, v60
    buffer_load_dwordx4 v[92:95], v1, s[12:15], s35 offen offset:2048
    buffer_load_dwordx4 v[184:187], v1, s[12:15], s35 offen offset:3072
    v_exp_f32 v61, v61
    v_exp_f32 v62, v62
    v_exp_f32 v63, v63
    v_exp_f32 v32, v32
    v_exp_f32 v33, v33
    v_smfmac_f32_32x32x32_bf16 v[16:31], v[140:143], v[56:63], v5
    v_exp_f32 v34, v34
    v_exp_f32 v35, v35
    v_exp_f32 v36, v36
    s_waitcnt vmcnt(9)
    v_mfma_f32_32x32x16_bf16 v[48:63], v[76:79], v[8:11], 0
    v_permlane16_swap_b32 v144, v148
    v_permlane16_swap_b32 v145, v149
    v_permlane16_swap_b32 v146, v150
    v_permlane16_swap_b32 v147, v151
    v_exp_f32 v37, v37
    v_exp_f32 v38, v38
    v_exp_f32 v39, v39
    v_exp_f32 v40, v40
    v_exp_f32 v41, v41
    v_smfmac_f32_32x32x32_bf16 v[16:31], v[144:147], v[32:39], v5
    v_exp_f32 v42, v42
    v_exp_f32 v43, v43
    v_exp_f32 v44, v44
    buffer_load_dwordx4 v[96:99], v1, s[12:15], s36 offen offset:0
    buffer_load_dwordx4 v[192:195], v1, s[12:15], s36 offen offset:1024
    v_exp_f32 v45, v45
    v_exp_f32 v46, v46
    v_exp_f32 v47, v47
    v_exp_f32 v48, v48
    v_exp_f32 v49, v49
    v_smfmac_f32_32x32x32_bf16 v[16:31], v[148:151], v[40:47], v5
    v_exp_f32 v50, v50
    v_exp_f32 v51, v51
    v_exp_f32 v52, v52
    s_waitcnt vmcnt(9)
    v_mfma_f32_32x32x16_bf16 v[32:47], v[80:83], v[8:11], 0
    v_permlane16_swap_b32 v152, v156
    v_permlane16_swap_b32 v153, v157
    v_permlane16_swap_b32 v154, v158
    v_permlane16_swap_b32 v155, v159
    v_exp_f32 v53, v53
    v_exp_f32 v54, v54
    v_exp_f32 v55, v55
    v_exp_f32 v56, v56
    v_exp_f32 v57, v57
    v_smfmac_f32_32x32x32_bf16 v[16:31], v[152:155], v[48:55], v5
    v_exp_f32 v58, v58
    v_exp_f32 v59, v59
    v_exp_f32 v60, v60
    buffer_load_dwordx4 v[100:103], v1, s[12:15], s36 offen offset:2048
    buffer_load_dwordx4 v[200:203], v1, s[12:15], s36 offen offset:3072
    v_exp_f32 v61, v61
    v_exp_f32 v62, v62
    v_exp_f32 v63, v63
    v_exp_f32 v32, v32
    v_exp_f32 v33, v33
    v_smfmac_f32_32x32x32_bf16 v[16:31], v[156:159], v[56:63], v5
    v_exp_f32 v34, v34
    v_exp_f32 v35, v35
    v_exp_f32 v36, v36
    s_waitcnt vmcnt(9)
    v_mfma_f32_32x32x16_bf16 v[48:63], v[84:87], v[8:11], 0
    v_permlane16_swap_b32 v160, v164
    v_permlane16_swap_b32 v161, v165
    v_permlane16_swap_b32 v162, v166
    v_permlane16_swap_b32 v163, v167
    v_exp_f32 v37, v37
    v_exp_f32 v38, v38
    v_exp_f32 v39, v39
    v_exp_f32 v40, v40
    v_exp_f32 v41, v41
    v_smfmac_f32_32x32x32_bf16 v[16:31], v[160:163], v[32:39], v5
    v_exp_f32 v42, v42
    v_exp_f32 v43, v43
    v_exp_f32 v44, v44
    buffer_load_dwordx4 v[104:107], v1, s[12:15], s37 offen offset:0
    buffer_load_dwordx4 v[208:211], v1, s[12:15], s37 offen offset:1024
    v_exp_f32 v45, v45
    v_exp_f32 v46, v46
    v_exp_f32 v47, v47
    v_exp_f32 v48, v48
    v_exp_f32 v49, v49
    v_smfmac_f32_32x32x32_bf16 v[16:31], v[164:167], v[40:47], v5
    v_exp_f32 v50, v50
    v_exp_f32 v51, v51
    v_exp_f32 v52, v52
    s_waitcnt vmcnt(9)
    v_mfma_f32_32x32x16_bf16 v[32:47], v[88:91], v[8:11], 0
    v_permlane16_swap_b32 v168, v172
    v_permlane16_swap_b32 v169, v173
    v_permlane16_swap_b32 v170, v174
    v_permlane16_swap_b32 v171, v175
    v_exp_f32 v53, v53
    v_exp_f32 v54, v54
    v_exp_f32 v55, v55
    v_exp_f32 v56, v56
    v_exp_f32 v57, v57
    v_smfmac_f32_32x32x32_bf16 v[16:31], v[168:171], v[48:55], v5
    v_exp_f32 v58, v58
    v_exp_f32 v59, v59
    v_exp_f32 v60, v60
    buffer_load_dwordx4 v[108:111], v1, s[12:15], s37 offen offset:2048
    buffer_load_dwordx4 v[216:219], v1, s[12:15], s37 offen offset:3072
    v_exp_f32 v61, v61
    v_exp_f32 v62, v62
    v_exp_f32 v63, v63
    v_exp_f32 v32, v32
    v_exp_f32 v33, v33
    v_smfmac_f32_32x32x32_bf16 v[16:31], v[172:175], v[56:63], v5
    v_exp_f32 v34, v34
    v_exp_f32 v35, v35
    v_exp_f32 v36, v36
    s_waitcnt vmcnt(9)
    v_mfma_f32_32x32x16_bf16 v[48:63], v[92:95], v[8:11], 0
    v_permlane16_swap_b32 v176, v180
    v_permlane16_swap_b32 v177, v181
    v_permlane16_swap_b32 v178, v182
    v_permlane16_swap_b32 v179, v183
    v_exp_f32 v37, v37
    v_exp_f32 v38, v38
    v_exp_f32 v39, v39
    v_exp_f32 v40, v40
    v_exp_f32 v41, v41
    v_smfmac_f32_32x32x32_bf16 v[16:31], v[176:179], v[32:39], v5
    v_exp_f32 v42, v42
    v_exp_f32 v43, v43
    v_exp_f32 v44, v44
    buffer_load_dwordx4 v[112:115], v1, s[12:15], s38 offen offset:0
    buffer_load_dwordx4 v[224:227], v1, s[12:15], s38 offen offset:1024
    v_exp_f32 v45, v45
    v_exp_f32 v46, v46
    v_exp_f32 v47, v47
    v_exp_f32 v48, v48
    v_exp_f32 v49, v49
    v_smfmac_f32_32x32x32_bf16 v[16:31], v[180:183], v[40:47], v5
    v_exp_f32 v50, v50
    v_exp_f32 v51, v51
    v_exp_f32 v52, v52
    s_waitcnt vmcnt(9)
    v_mfma_f32_32x32x16_bf16 v[32:47], v[96:99], v[8:11], 0
    v_permlane16_swap_b32 v184, v188
    v_permlane16_swap_b32 v185, v189
    v_permlane16_swap_b32 v186, v190
    v_permlane16_swap_b32 v187, v191
    v_exp_f32 v53, v53
    v_exp_f32 v54, v54
    v_exp_f32 v55, v55
    v_exp_f32 v56, v56
    v_exp_f32 v57, v57
    v_smfmac_f32_32x32x32_bf16 v[16:31], v[184:187], v[48:55], v5
    v_exp_f32 v58, v58
    v_exp_f32 v59, v59
    v_exp_f32 v60, v60
    buffer_load_dwordx4 v[116:119], v1, s[12:15], s38 offen offset:2048
    buffer_load_dwordx4 v[232:235], v1, s[12:15], s38 offen offset:3072
    v_exp_f32 v61, v61
    v_exp_f32 v62, v62
    v_exp_f32 v63, v63
    v_exp_f32 v32, v32
    v_exp_f32 v33, v33
    v_smfmac_f32_32x32x32_bf16 v[16:31], v[188:191], v[56:63], v5
    v_exp_f32 v34, v34
    v_exp_f32 v35, v35
    v_exp_f32 v36, v36
    s_waitcnt vmcnt(9)
    v_mfma_f32_32x32x16_bf16 v[48:63], v[100:103], v[8:11], 0
    v_permlane16_swap_b32 v192, v196
    v_permlane16_swap_b32 v193, v197
    v_permlane16_swap_b32 v194, v198
    v_permlane16_swap_b32 v195, v199
    v_exp_f32 v37, v37
    v_exp_f32 v38, v38
    v_exp_f32 v39, v39
    v_exp_f32 v40, v40
    v_exp_f32 v41, v41
    v_smfmac_f32_32x32x32_bf16 v[16:31], v[192:195], v[32:39], v5
    v_exp_f32 v42, v42
    v_exp_f32 v43, v43
    v_exp_f32 v44, v44
    buffer_load_dwordx4 v[120:123], v1, s[12:15], s39 offen offset:0
    buffer_load_dwordx4 v[240:243], v1, s[12:15], s39 offen offset:1024
    v_exp_f32 v45, v45
    v_exp_f32 v46, v46
    v_exp_f32 v47, v47
    v_exp_f32 v48, v48
    v_exp_f32 v49, v49
    v_smfmac_f32_32x32x32_bf16 v[16:31], v[196:199], v[40:47], v5
    v_exp_f32 v50, v50
    v_exp_f32 v51, v51
    v_exp_f32 v52, v52
    s_waitcnt vmcnt(9)
    v_mfma_f32_32x32x16_bf16 v[32:47], v[104:107], v[8:11], 0
    v_permlane16_swap_b32 v200, v204
    v_permlane16_swap_b32 v201, v205
    v_permlane16_swap_b32 v202, v206
    v_permlane16_swap_b32 v203, v207
    v_exp_f32 v53, v53
    v_exp_f32 v54, v54
    v_exp_f32 v55, v55
    v_exp_f32 v56, v56
    v_exp_f32 v57, v57
    v_smfmac_f32_32x32x32_bf16 v[16:31], v[200:203], v[48:55], v5
    v_exp_f32 v58, v58
    v_exp_f32 v59, v59
    v_exp_f32 v60, v60
    buffer_load_dwordx4 v[124:127], v1, s[12:15], s39 offen offset:2048
    buffer_load_dwordx4 v[248:251], v1, s[12:15], s39 offen offset:3072
    v_exp_f32 v61, v61
    v_exp_f32 v62, v62
    v_exp_f32 v63, v63
    v_exp_f32 v32, v32
    v_exp_f32 v33, v33
    v_smfmac_f32_32x32x32_bf16 v[16:31], v[204:207], v[56:63], v5
    v_exp_f32 v34, v34
    v_exp_f32 v35, v35
    v_exp_f32 v36, v36
    s_waitcnt vmcnt(9)
    v_mfma_f32_32x32x16_bf16 v[48:63], v[108:111], v[8:11], 0
    v_permlane16_swap_b32 v208, v212
    v_permlane16_swap_b32 v209, v213
    v_permlane16_swap_b32 v210, v214
    v_permlane16_swap_b32 v211, v215
    v_exp_f32 v37, v37
    v_exp_f32 v38, v38
    v_exp_f32 v39, v39
    v_exp_f32 v40, v40
    v_exp_f32 v41, v41
    v_smfmac_f32_32x32x32_bf16 v[16:31], v[208:211], v[32:39], v5
    v_exp_f32 v42, v42
    v_exp_f32 v43, v43
    v_exp_f32 v44, v44
    s_barrier
    v_exp_f32 v45, v45
    v_exp_f32 v46, v46
    v_exp_f32 v47, v47
    v_exp_f32 v48, v48
    v_exp_f32 v49, v49
    v_smfmac_f32_32x32x32_bf16 v[16:31], v[212:215], v[40:47], v5
    v_exp_f32 v50, v50
    v_exp_f32 v51, v51
    v_exp_f32 v52, v52
    s_waitcnt vmcnt(7)
    v_mfma_f32_32x32x16_bf16 v[32:47], v[112:115], v[8:11], 0
    v_permlane16_swap_b32 v216, v220
    v_permlane16_swap_b32 v217, v221
    v_permlane16_swap_b32 v218, v222
    v_permlane16_swap_b32 v219, v223
    v_exp_f32 v53, v53
    v_exp_f32 v54, v54
    v_exp_f32 v55, v55
    v_exp_f32 v56, v56
    v_exp_f32 v57, v57
    v_smfmac_f32_32x32x32_bf16 v[16:31], v[216:219], v[48:55], v5
    v_exp_f32 v58, v58
    v_exp_f32 v59, v59
    v_exp_f32 v60, v60
    v_exp_f32 v61, v61
    v_exp_f32 v62, v62
    v_exp_f32 v63, v63
    v_exp_f32 v32, v32
    v_exp_f32 v33, v33
    v_smfmac_f32_32x32x32_bf16 v[16:31], v[220:223], v[56:63], v5
    v_exp_f32 v34, v34
    v_exp_f32 v35, v35
    v_exp_f32 v36, v36
    s_waitcnt vmcnt(5)
    v_mfma_f32_32x32x16_bf16 v[48:63], v[116:119], v[8:11], 0
    v_permlane16_swap_b32 v224, v228
    v_permlane16_swap_b32 v225, v229
    v_permlane16_swap_b32 v226, v230
    v_permlane16_swap_b32 v227, v231
    v_exp_f32 v37, v37
    v_exp_f32 v38, v38
    v_exp_f32 v39, v39
    v_exp_f32 v40, v40
    v_exp_f32 v41, v41
    v_smfmac_f32_32x32x32_bf16 v[16:31], v[224:227], v[32:39], v5
    v_exp_f32 v42, v42
    v_exp_f32 v43, v43
    v_exp_f32 v44, v44
    v_exp_f32 v45, v45
    v_exp_f32 v46, v46
    v_exp_f32 v47, v47
    v_exp_f32 v48, v48
    v_exp_f32 v49, v49
    v_smfmac_f32_32x32x32_bf16 v[16:31], v[228:231], v[40:47], v5
    v_exp_f32 v50, v50
    v_exp_f32 v51, v51
    v_exp_f32 v52, v52
    s_waitcnt vmcnt(3)
    v_mfma_f32_32x32x16_bf16 v[32:47], v[120:123], v[8:11], 0
    v_permlane16_swap_b32 v232, v236
    v_permlane16_swap_b32 v233, v237
    v_permlane16_swap_b32 v234, v238
    v_permlane16_swap_b32 v235, v239
    v_exp_f32 v53, v53
    v_exp_f32 v54, v54
    v_exp_f32 v55, v55
    v_exp_f32 v56, v56
    v_exp_f32 v57, v57
    v_smfmac_f32_32x32x32_bf16 v[16:31], v[232:235], v[48:55], v5
    v_exp_f32 v58, v58
    v_exp_f32 v59, v59
    v_exp_f32 v60, v60
    v_exp_f32 v61, v61
    v_exp_f32 v62, v62
    v_exp_f32 v63, v63
    v_exp_f32 v32, v32
    v_exp_f32 v33, v33
    v_smfmac_f32_32x32x32_bf16 v[16:31], v[236:239], v[56:63], v5
    v_exp_f32 v34, v34
    v_exp_f32 v35, v35
    v_exp_f32 v36, v36
    s_waitcnt vmcnt(1)
    v_mfma_f32_32x32x16_bf16 v[48:63], v[124:127], v[8:11], 0
    v_permlane16_swap_b32 v240, v244
    v_permlane16_swap_b32 v241, v245
    v_permlane16_swap_b32 v242, v246
    v_permlane16_swap_b32 v243, v247
    ds_read_b128 v[8:11], v1 offset:1024
    v_exp_f32 v37, v37
    v_exp_f32 v38, v38
    v_exp_f32 v39, v39
    v_exp_f32 v40, v40
    v_exp_f32 v41, v41
    v_smfmac_f32_32x32x32_bf16 v[16:31], v[240:243], v[32:39], v5
    v_exp_f32 v42, v42
    v_exp_f32 v43, v43
    v_exp_f32 v44, v44
    v_exp_f32 v45, v45
    v_exp_f32 v46, v46
    v_exp_f32 v47, v47
    v_exp_f32 v48, v48
    v_exp_f32 v49, v49
    v_smfmac_f32_32x32x32_bf16 v[16:31], v[244:247], v[40:47], v5
    v_exp_f32 v50, v50
    v_exp_f32 v51, v51
    v_exp_f32 v52, v52
    s_waitcnt vmcnt(0)
    s_waitcnt lgkmcnt(0)
    v_mfma_f32_32x32x16_bf16 v[32:47], v[64:67], v[8:11], 0
    v_permlane16_swap_b32 v248, v252
    v_permlane16_swap_b32 v249, v253
    v_permlane16_swap_b32 v250, v254
    v_permlane16_swap_b32 v251, v255
    v_exp_f32 v53, v53
    v_exp_f32 v54, v54
    v_exp_f32 v55, v55
    v_exp_f32 v56, v56
    v_exp_f32 v57, v57
    v_smfmac_f32_32x32x32_bf16 v[16:31], v[248:251], v[48:55], v5
    v_exp_f32 v58, v58
    v_exp_f32 v59, v59
    v_exp_f32 v60, v60
    v_exp_f32 v61, v61
    v_exp_f32 v62, v62
    v_exp_f32 v63, v63
    v_exp_f32 v32, v32
    v_exp_f32 v33, v33
    v_smfmac_f32_32x32x32_bf16 v[16:31], v[252:255], v[56:63], v5
    v_exp_f32 v34, v34
    v_exp_f32 v35, v35
    v_exp_f32 v36, v36
    v_mfma_f32_32x32x16_bf16 v[48:63], v[68:71], v[8:11], 0
    v_exp_f32 v37, v37
    v_exp_f32 v38, v38
    v_exp_f32 v39, v39
    v_exp_f32 v40, v40
    v_exp_f32 v41, v41
    v_exp_f32 v42, v42
    v_exp_f32 v43, v43
    v_exp_f32 v44, v44
    ds_write_addtid_b32 v16 offset:8192
    ds_write_addtid_b32 v17 offset:8448
    ds_write_addtid_b32 v18 offset:8704
    v_exp_f32 v45, v45
    ds_write_addtid_b32 v19 offset:8960
    ds_write_addtid_b32 v20 offset:9216
    ds_write_addtid_b32 v21 offset:9472
    v_exp_f32 v46, v46
    ds_write_addtid_b32 v22 offset:9728
    ds_write_addtid_b32 v23 offset:9984
    ds_write_addtid_b32 v24 offset:10240
    v_mfma_f32_32x32x8_bf16 v[16:31], v[6:7], v[6:7], 0
    v_exp_f32 v47, v47
    v_exp_f32 v48, v48
    v_exp_f32 v49, v49
    v_exp_f32 v50, v50
    v_smfmac_f32_32x32x32_bf16 v[16:31], v[128:131], v[32:39], v5
    v_exp_f32 v51, v51
    v_exp_f32 v52, v52
    v_exp_f32 v53, v53
    v_smfmac_f32_32x32x32_bf16 v[16:31], v[132:135], v[40:47], v5
    v_exp_f32 v54, v54
    v_exp_f32 v55, v55
    v_exp_f32 v56, v56
    v_mfma_f32_32x32x16_bf16 v[32:47], v[72:75], v[8:11], 0
    ds_write_addtid_b32 v5 offset:10496
    v_exp_f32 v57, v57
    v_exp_f32 v58, v58
    v_exp_f32 v59, v59
    v_smfmac_f32_32x32x32_bf16 v[16:31], v[136:139], v[48:55], v5
    v_exp_f32 v60, v60
    v_exp_f32 v61, v61
    v_exp_f32 v62, v62
    v_exp_f32 v63, v63
    s_nop 2
    v_exp_f32 v32, v32
    v_exp_f32 v33, v33
    v_smfmac_f32_32x32x32_bf16 v[16:31], v[140:143], v[56:63], v5
    v_exp_f32 v34, v34
    v_exp_f32 v35, v35
    v_exp_f32 v36, v36
    v_mfma_f32_32x32x16_bf16 v[48:63], v[76:79], v[8:11], 0
    v_exp_f32 v37, v37
    v_exp_f32 v38, v38
    v_exp_f32 v39, v39
    v_exp_f32 v40, v40
    v_exp_f32 v41, v41
    v_smfmac_f32_32x32x32_bf16 v[16:31], v[144:147], v[32:39], v5
    v_exp_f32 v42, v42
    v_exp_f32 v43, v43
    v_exp_f32 v44, v44
    v_exp_f32 v45, v45
    v_exp_f32 v46, v46
    v_exp_f32 v47, v47
    v_exp_f32 v48, v48
    v_exp_f32 v49, v49
    v_smfmac_f32_32x32x32_bf16 v[16:31], v[148:151], v[40:47], v5
    v_exp_f32 v50, v50
    v_exp_f32 v51, v51
    v_exp_f32 v52, v52
    v_mfma_f32_32x32x16_bf16 v[32:47], v[80:83], v[8:11], 0
    v_exp_f32 v53, v53
    v_exp_f32 v54, v54
    v_exp_f32 v55, v55
    v_exp_f32 v56, v56
    v_exp_f32 v57, v57
    v_smfmac_f32_32x32x32_bf16 v[16:31], v[152:155], v[48:55], v5
    v_exp_f32 v58, v58
    v_exp_f32 v59, v59
    v_exp_f32 v60, v60
    v_exp_f32 v61, v61
    v_exp_f32 v62, v62
    v_exp_f32 v63, v63
    v_exp_f32 v32, v32
    v_exp_f32 v33, v33
    v_smfmac_f32_32x32x32_bf16 v[16:31], v[156:159], v[56:63], v5
    v_exp_f32 v34, v34
    v_exp_f32 v35, v35
    v_exp_f32 v36, v36
    v_mfma_f32_32x32x16_bf16 v[48:63], v[84:87], v[8:11], 0
    v_exp_f32 v37, v37
    v_exp_f32 v38, v38
    v_exp_f32 v39, v39
    v_exp_f32 v40, v40
    v_exp_f32 v41, v41
    v_smfmac_f32_32x32x32_bf16 v[16:31], v[160:163], v[32:39], v5
    v_exp_f32 v42, v42
    v_exp_f32 v43, v43
    v_exp_f32 v44, v44
    v_exp_f32 v45, v45
    v_exp_f32 v46, v46
    v_exp_f32 v47, v47
    v_exp_f32 v48, v48
    v_exp_f32 v49, v49
    v_smfmac_f32_32x32x32_bf16 v[16:31], v[164:167], v[40:47], v5
    v_exp_f32 v50, v50
    v_exp_f32 v51, v51
    v_exp_f32 v52, v52
    v_mfma_f32_32x32x16_bf16 v[32:47], v[88:91], v[8:11], 0
    v_exp_f32 v53, v53
    v_exp_f32 v54, v54
    v_exp_f32 v55, v55
    v_exp_f32 v56, v56
    v_exp_f32 v57, v57
    v_smfmac_f32_32x32x32_bf16 v[16:31], v[168:171], v[48:55], v5
    v_exp_f32 v58, v58
    v_exp_f32 v59, v59
    v_exp_f32 v60, v60
    v_exp_f32 v61, v61
    v_exp_f32 v62, v62
    v_exp_f32 v63, v63
    v_exp_f32 v32, v32
    v_exp_f32 v33, v33
    v_smfmac_f32_32x32x32_bf16 v[16:31], v[172:175], v[56:63], v5
    v_exp_f32 v34, v34
    v_exp_f32 v35, v35
    v_exp_f32 v36, v36
    v_mfma_f32_32x32x16_bf16 v[48:63], v[92:95], v[8:11], 0
    v_exp_f32 v37, v37
    v_exp_f32 v38, v38
    v_exp_f32 v39, v39
    v_exp_f32 v40, v40
    v_exp_f32 v41, v41
    v_smfmac_f32_32x32x32_bf16 v[16:31], v[176:179], v[32:39], v5
    v_exp_f32 v42, v42
    v_exp_f32 v43, v43
    v_exp_f32 v44, v44
    v_exp_f32 v45, v45
    v_exp_f32 v46, v46
    v_exp_f32 v47, v47
    v_exp_f32 v48, v48
    v_exp_f32 v49, v49
    v_smfmac_f32_32x32x32_bf16 v[16:31], v[180:183], v[40:47], v5
    v_exp_f32 v50, v50
    v_exp_f32 v51, v51
    v_exp_f32 v52, v52
    v_mfma_f32_32x32x16_bf16 v[32:47], v[96:99], v[8:11], 0
    v_exp_f32 v53, v53
    v_exp_f32 v54, v54
    v_exp_f32 v55, v55
    v_exp_f32 v56, v56
    v_exp_f32 v57, v57
    v_smfmac_f32_32x32x32_bf16 v[16:31], v[184:187], v[48:55], v5
    v_exp_f32 v58, v58
    v_exp_f32 v59, v59
    v_exp_f32 v60, v60
    v_exp_f32 v61, v61
    v_exp_f32 v62, v62
    v_exp_f32 v63, v63
    v_exp_f32 v32, v32
    v_exp_f32 v33, v33
    v_smfmac_f32_32x32x32_bf16 v[16:31], v[188:191], v[56:63], v5
    v_exp_f32 v34, v34
    v_exp_f32 v35, v35
    v_exp_f32 v36, v36
    v_mfma_f32_32x32x16_bf16 v[48:63], v[100:103], v[8:11], 0
    v_exp_f32 v37, v37
    v_exp_f32 v38, v38
    v_exp_f32 v39, v39
    v_exp_f32 v40, v40
    v_exp_f32 v41, v41
    v_smfmac_f32_32x32x32_bf16 v[16:31], v[192:195], v[32:39], v5
    v_exp_f32 v42, v42
    v_exp_f32 v43, v43
    v_exp_f32 v44, v44
    v_exp_f32 v45, v45
    v_exp_f32 v46, v46
    v_exp_f32 v47, v47
    v_exp_f32 v48, v48
    v_exp_f32 v49, v49
    v_smfmac_f32_32x32x32_bf16 v[16:31], v[196:199], v[40:47], v5
    v_exp_f32 v50, v50
    v_exp_f32 v51, v51
    v_exp_f32 v52, v52
    v_mfma_f32_32x32x16_bf16 v[32:47], v[104:107], v[8:11], 0
    v_exp_f32 v53, v53
    v_exp_f32 v54, v54
    v_exp_f32 v55, v55
    v_exp_f32 v56, v56
    v_exp_f32 v57, v57
    v_smfmac_f32_32x32x32_bf16 v[16:31], v[200:203], v[48:55], v5
    v_exp_f32 v58, v58
    v_exp_f32 v59, v59
    v_exp_f32 v60, v60
    v_exp_f32 v61, v61
    v_exp_f32 v62, v62
    v_exp_f32 v63, v63
    v_exp_f32 v32, v32
    v_exp_f32 v33, v33
    v_smfmac_f32_32x32x32_bf16 v[16:31], v[204:207], v[56:63], v5
    v_exp_f32 v34, v34
    v_exp_f32 v35, v35
    v_exp_f32 v36, v36
    v_mfma_f32_32x32x16_bf16 v[48:63], v[108:111], v[8:11], 0
    v_exp_f32 v37, v37
    v_exp_f32 v38, v38
    v_exp_f32 v39, v39
    v_exp_f32 v40, v40
    v_exp_f32 v41, v41
    v_smfmac_f32_32x32x32_bf16 v[16:31], v[208:211], v[32:39], v5
    v_exp_f32 v42, v42
    v_exp_f32 v43, v43
    v_exp_f32 v44, v44
    v_exp_f32 v45, v45
    v_exp_f32 v46, v46
    v_exp_f32 v47, v47
    v_exp_f32 v48, v48
    v_exp_f32 v49, v49
    v_smfmac_f32_32x32x32_bf16 v[16:31], v[212:215], v[40:47], v5
    v_exp_f32 v50, v50
    v_exp_f32 v51, v51
    v_exp_f32 v52, v52
    v_mfma_f32_32x32x16_bf16 v[32:47], v[112:115], v[8:11], 0
    v_exp_f32 v53, v53
    v_exp_f32 v54, v54
    v_exp_f32 v55, v55
    v_exp_f32 v56, v56
    v_exp_f32 v57, v57
    v_smfmac_f32_32x32x32_bf16 v[16:31], v[216:219], v[48:55], v5
    v_exp_f32 v58, v58
    v_exp_f32 v59, v59
    v_exp_f32 v60, v60
    v_exp_f32 v61, v61
    v_exp_f32 v62, v62
    v_exp_f32 v63, v63
    v_exp_f32 v32, v32
    v_exp_f32 v33, v33
    v_smfmac_f32_32x32x32_bf16 v[16:31], v[220:223], v[56:63], v5
    v_exp_f32 v34, v34
    v_exp_f32 v35, v35
    v_exp_f32 v36, v36
    v_mfma_f32_32x32x16_bf16 v[48:63], v[116:119], v[8:11], 0
    v_exp_f32 v37, v37
    v_exp_f32 v38, v38
    v_exp_f32 v39, v39
    v_exp_f32 v40, v40
    v_exp_f32 v41, v41
    v_smfmac_f32_32x32x32_bf16 v[16:31], v[224:227], v[32:39], v5
    v_exp_f32 v42, v42
    v_exp_f32 v43, v43
    v_exp_f32 v44, v44
    v_exp_f32 v45, v45
    v_exp_f32 v46, v46
    v_exp_f32 v47, v47
    v_exp_f32 v48, v48
    v_exp_f32 v49, v49
    v_smfmac_f32_32x32x32_bf16 v[16:31], v[228:231], v[40:47], v5
    v_exp_f32 v50, v50
    v_exp_f32 v51, v51
    v_exp_f32 v52, v52
    v_mfma_f32_32x32x16_bf16 v[32:47], v[120:123], v[8:11], 0
    v_exp_f32 v53, v53
    v_exp_f32 v54, v54
    v_exp_f32 v55, v55
    v_exp_f32 v56, v56
    v_exp_f32 v57, v57
    v_smfmac_f32_32x32x32_bf16 v[16:31], v[232:235], v[48:55], v5
    v_exp_f32 v58, v58
    v_exp_f32 v59, v59
    v_exp_f32 v60, v60
    v_exp_f32 v61, v61
    v_exp_f32 v62, v62
    v_exp_f32 v63, v63
    v_exp_f32 v32, v32
    v_exp_f32 v33, v33
    v_smfmac_f32_32x32x32_bf16 v[16:31], v[236:239], v[56:63], v5
    v_exp_f32 v34, v34
    v_exp_f32 v35, v35
    v_exp_f32 v36, v36
    v_mfma_f32_32x32x16_bf16 v[48:63], v[124:127], v[8:11], 0
    ds_read_b128 v[8:11], v1 offset:2048
    v_exp_f32 v37, v37
    v_exp_f32 v38, v38
    v_exp_f32 v39, v39
    v_exp_f32 v40, v40
    v_exp_f32 v41, v41
    v_smfmac_f32_32x32x32_bf16 v[16:31], v[240:243], v[32:39], v5
    v_exp_f32 v42, v42
    v_exp_f32 v43, v43
    v_exp_f32 v44, v44
    v_exp_f32 v45, v45
    v_exp_f32 v46, v46
    v_exp_f32 v47, v47
    v_exp_f32 v48, v48
    v_exp_f32 v49, v49
    v_smfmac_f32_32x32x32_bf16 v[16:31], v[244:247], v[40:47], v5
    v_exp_f32 v50, v50
    v_exp_f32 v51, v51
    v_exp_f32 v52, v52
    s_waitcnt lgkmcnt(0)
    v_mfma_f32_32x32x16_bf16 v[32:47], v[64:67], v[8:11], 0
    v_exp_f32 v53, v53
    v_exp_f32 v54, v54
    v_exp_f32 v55, v55
    v_exp_f32 v56, v56
    v_exp_f32 v57, v57
    v_smfmac_f32_32x32x32_bf16 v[16:31], v[248:251], v[48:55], v5
    v_exp_f32 v58, v58
    v_exp_f32 v59, v59
    v_exp_f32 v60, v60
    v_exp_f32 v61, v61
    v_exp_f32 v62, v62
    v_exp_f32 v63, v63
    v_exp_f32 v32, v32
    v_exp_f32 v33, v33
    v_smfmac_f32_32x32x32_bf16 v[16:31], v[252:255], v[56:63], v5
    v_exp_f32 v34, v34
    v_exp_f32 v35, v35
    v_exp_f32 v36, v36
    v_mfma_f32_32x32x16_bf16 v[48:63], v[68:71], v[8:11], 0
    v_exp_f32 v37, v37
    v_exp_f32 v38, v38
    v_exp_f32 v39, v39
    v_exp_f32 v40, v40
    v_exp_f32 v41, v41
    v_exp_f32 v42, v42
    v_exp_f32 v43, v43
    v_exp_f32 v44, v44
    ds_write_addtid_b32 v16 offset:10752
    ds_write_addtid_b32 v17 offset:11008
    ds_write_addtid_b32 v18 offset:11264
    v_exp_f32 v45, v45
    ds_write_addtid_b32 v19 offset:11520
    ds_write_addtid_b32 v20 offset:11776
    ds_write_addtid_b32 v21 offset:12032
    v_exp_f32 v46, v46
    ds_write_addtid_b32 v22 offset:12288
    ds_write_addtid_b32 v23 offset:12544
    ds_write_addtid_b32 v24 offset:12800
    v_mfma_f32_32x32x8_bf16 v[16:31], v[6:7], v[6:7], 0
    v_exp_f32 v47, v47
    v_exp_f32 v48, v48
    v_exp_f32 v49, v49
    v_exp_f32 v50, v50
    v_smfmac_f32_32x32x32_bf16 v[16:31], v[128:131], v[32:39], v5
    v_exp_f32 v51, v51
    v_exp_f32 v52, v52
    v_exp_f32 v53, v53
    v_smfmac_f32_32x32x32_bf16 v[16:31], v[132:135], v[40:47], v5
    v_exp_f32 v54, v54
    v_exp_f32 v55, v55
    v_exp_f32 v56, v56
    v_mfma_f32_32x32x16_bf16 v[32:47], v[72:75], v[8:11], 0
    ds_write_addtid_b32 v5 offset:13056
    v_exp_f32 v57, v57
    v_exp_f32 v58, v58
    v_exp_f32 v59, v59
    v_smfmac_f32_32x32x32_bf16 v[16:31], v[136:139], v[48:55], v5
    v_exp_f32 v60, v60
    v_exp_f32 v61, v61
    v_exp_f32 v62, v62
    v_exp_f32 v63, v63
    s_nop 2
    v_exp_f32 v32, v32
    v_exp_f32 v33, v33
    v_smfmac_f32_32x32x32_bf16 v[16:31], v[140:143], v[56:63], v5
    v_exp_f32 v34, v34
    v_exp_f32 v35, v35
    v_exp_f32 v36, v36
    v_mfma_f32_32x32x16_bf16 v[48:63], v[76:79], v[8:11], 0
    v_exp_f32 v37, v37
    v_exp_f32 v38, v38
    v_exp_f32 v39, v39
    v_exp_f32 v40, v40
    v_exp_f32 v41, v41
    v_smfmac_f32_32x32x32_bf16 v[16:31], v[144:147], v[32:39], v5
    v_exp_f32 v42, v42
    v_exp_f32 v43, v43
    v_exp_f32 v44, v44
    v_exp_f32 v45, v45
    v_exp_f32 v46, v46
    v_exp_f32 v47, v47
    v_exp_f32 v48, v48
    v_exp_f32 v49, v49
    v_smfmac_f32_32x32x32_bf16 v[16:31], v[148:151], v[40:47], v5
    v_exp_f32 v50, v50
    v_exp_f32 v51, v51
    v_exp_f32 v52, v52
    v_mfma_f32_32x32x16_bf16 v[32:47], v[80:83], v[8:11], 0
    v_exp_f32 v53, v53
    v_exp_f32 v54, v54
    v_exp_f32 v55, v55
    v_exp_f32 v56, v56
    v_exp_f32 v57, v57
    v_smfmac_f32_32x32x32_bf16 v[16:31], v[152:155], v[48:55], v5
    v_exp_f32 v58, v58
    v_exp_f32 v59, v59
    v_exp_f32 v60, v60
    v_exp_f32 v61, v61
    v_exp_f32 v62, v62
    v_exp_f32 v63, v63
    v_exp_f32 v32, v32
    v_exp_f32 v33, v33
    v_smfmac_f32_32x32x32_bf16 v[16:31], v[156:159], v[56:63], v5
    v_exp_f32 v34, v34
    v_exp_f32 v35, v35
    v_exp_f32 v36, v36
    v_mfma_f32_32x32x16_bf16 v[48:63], v[84:87], v[8:11], 0
    v_exp_f32 v37, v37
    v_exp_f32 v38, v38
    v_exp_f32 v39, v39
    v_exp_f32 v40, v40
    v_exp_f32 v41, v41
    v_smfmac_f32_32x32x32_bf16 v[16:31], v[160:163], v[32:39], v5
    v_exp_f32 v42, v42
    v_exp_f32 v43, v43
    v_exp_f32 v44, v44
    v_exp_f32 v45, v45
    v_exp_f32 v46, v46
    v_exp_f32 v47, v47
    v_exp_f32 v48, v48
    v_exp_f32 v49, v49
    v_smfmac_f32_32x32x32_bf16 v[16:31], v[164:167], v[40:47], v5
    v_exp_f32 v50, v50
    v_exp_f32 v51, v51
    v_exp_f32 v52, v52
    v_mfma_f32_32x32x16_bf16 v[32:47], v[88:91], v[8:11], 0
    v_exp_f32 v53, v53
    v_exp_f32 v54, v54
    v_exp_f32 v55, v55
    v_exp_f32 v56, v56
    v_exp_f32 v57, v57
    v_smfmac_f32_32x32x32_bf16 v[16:31], v[168:171], v[48:55], v5
    v_exp_f32 v58, v58
    v_exp_f32 v59, v59
    v_exp_f32 v60, v60
    v_exp_f32 v61, v61
    v_exp_f32 v62, v62
    v_exp_f32 v63, v63
    v_exp_f32 v32, v32
    v_exp_f32 v33, v33
    v_smfmac_f32_32x32x32_bf16 v[16:31], v[172:175], v[56:63], v5
    v_exp_f32 v34, v34
    v_exp_f32 v35, v35
    v_exp_f32 v36, v36
    v_mfma_f32_32x32x16_bf16 v[48:63], v[92:95], v[8:11], 0
    v_exp_f32 v37, v37
    v_exp_f32 v38, v38
    v_exp_f32 v39, v39
    v_exp_f32 v40, v40
    v_exp_f32 v41, v41
    v_smfmac_f32_32x32x32_bf16 v[16:31], v[176:179], v[32:39], v5
    v_exp_f32 v42, v42
    v_exp_f32 v43, v43
    v_exp_f32 v44, v44
    v_exp_f32 v45, v45
    v_exp_f32 v46, v46
    v_exp_f32 v47, v47
    v_exp_f32 v48, v48
    v_exp_f32 v49, v49
    v_smfmac_f32_32x32x32_bf16 v[16:31], v[180:183], v[40:47], v5
    v_exp_f32 v50, v50
    v_exp_f32 v51, v51
    v_exp_f32 v52, v52
    v_mfma_f32_32x32x16_bf16 v[32:47], v[96:99], v[8:11], 0
    v_exp_f32 v53, v53
    v_exp_f32 v54, v54
    v_exp_f32 v55, v55
    v_exp_f32 v56, v56
    v_exp_f32 v57, v57
    v_smfmac_f32_32x32x32_bf16 v[16:31], v[184:187], v[48:55], v5
    v_exp_f32 v58, v58
    v_exp_f32 v59, v59
    v_exp_f32 v60, v60
    v_exp_f32 v61, v61
    v_exp_f32 v62, v62
    v_exp_f32 v63, v63
    v_exp_f32 v32, v32
    v_exp_f32 v33, v33
    v_smfmac_f32_32x32x32_bf16 v[16:31], v[188:191], v[56:63], v5
    v_exp_f32 v34, v34
    v_exp_f32 v35, v35
    v_exp_f32 v36, v36
    v_mfma_f32_32x32x16_bf16 v[48:63], v[100:103], v[8:11], 0
    v_exp_f32 v37, v37
    v_exp_f32 v38, v38
    v_exp_f32 v39, v39
    v_exp_f32 v40, v40
    v_exp_f32 v41, v41
    v_smfmac_f32_32x32x32_bf16 v[16:31], v[192:195], v[32:39], v5
    v_exp_f32 v42, v42
    v_exp_f32 v43, v43
    v_exp_f32 v44, v44
    v_exp_f32 v45, v45
    v_exp_f32 v46, v46
    v_exp_f32 v47, v47
    v_exp_f32 v48, v48
    v_exp_f32 v49, v49
    v_smfmac_f32_32x32x32_bf16 v[16:31], v[196:199], v[40:47], v5
    v_exp_f32 v50, v50
    v_exp_f32 v51, v51
    v_exp_f32 v52, v52
    v_mfma_f32_32x32x16_bf16 v[32:47], v[104:107], v[8:11], 0
    v_exp_f32 v53, v53
    v_exp_f32 v54, v54
    v_exp_f32 v55, v55
    v_exp_f32 v56, v56
    v_exp_f32 v57, v57
    v_smfmac_f32_32x32x32_bf16 v[16:31], v[200:203], v[48:55], v5
    v_exp_f32 v58, v58
    v_exp_f32 v59, v59
    v_exp_f32 v60, v60
    v_exp_f32 v61, v61
    v_exp_f32 v62, v62
    v_exp_f32 v63, v63
    v_exp_f32 v32, v32
    v_exp_f32 v33, v33
    v_smfmac_f32_32x32x32_bf16 v[16:31], v[204:207], v[56:63], v5
    v_exp_f32 v34, v34
    v_exp_f32 v35, v35
    v_exp_f32 v36, v36
    v_mfma_f32_32x32x16_bf16 v[48:63], v[108:111], v[8:11], 0
    v_exp_f32 v37, v37
    v_exp_f32 v38, v38
    v_exp_f32 v39, v39
    v_exp_f32 v40, v40
    v_exp_f32 v41, v41
    v_smfmac_f32_32x32x32_bf16 v[16:31], v[208:211], v[32:39], v5
    v_exp_f32 v42, v42
    v_exp_f32 v43, v43
    v_exp_f32 v44, v44
    v_exp_f32 v45, v45
    v_exp_f32 v46, v46
    v_exp_f32 v47, v47
    v_exp_f32 v48, v48
    v_exp_f32 v49, v49
    v_smfmac_f32_32x32x32_bf16 v[16:31], v[212:215], v[40:47], v5
    v_exp_f32 v50, v50
    v_exp_f32 v51, v51
    v_exp_f32 v52, v52
    v_mfma_f32_32x32x16_bf16 v[32:47], v[112:115], v[8:11], 0
    v_exp_f32 v53, v53
    v_exp_f32 v54, v54
    v_exp_f32 v55, v55
    v_exp_f32 v56, v56
    v_exp_f32 v57, v57
    v_smfmac_f32_32x32x32_bf16 v[16:31], v[216:219], v[48:55], v5
    v_exp_f32 v58, v58
    v_exp_f32 v59, v59
    v_exp_f32 v60, v60
    v_exp_f32 v61, v61
    v_exp_f32 v62, v62
    v_exp_f32 v63, v63
    v_exp_f32 v32, v32
    v_exp_f32 v33, v33
    v_smfmac_f32_32x32x32_bf16 v[16:31], v[220:223], v[56:63], v5
    v_exp_f32 v34, v34
    v_exp_f32 v35, v35
    v_exp_f32 v36, v36
    v_mfma_f32_32x32x16_bf16 v[48:63], v[116:119], v[8:11], 0
    v_exp_f32 v37, v37
    v_exp_f32 v38, v38
    v_exp_f32 v39, v39
    v_exp_f32 v40, v40
    v_exp_f32 v41, v41
    v_smfmac_f32_32x32x32_bf16 v[16:31], v[224:227], v[32:39], v5
    v_exp_f32 v42, v42
    v_exp_f32 v43, v43
    v_exp_f32 v44, v44
    v_exp_f32 v45, v45
    v_exp_f32 v46, v46
    v_exp_f32 v47, v47
    v_exp_f32 v48, v48
    v_exp_f32 v49, v49
    v_smfmac_f32_32x32x32_bf16 v[16:31], v[228:231], v[40:47], v5
    v_exp_f32 v50, v50
    v_exp_f32 v51, v51
    v_exp_f32 v52, v52
    v_mfma_f32_32x32x16_bf16 v[32:47], v[120:123], v[8:11], 0
    v_exp_f32 v53, v53
    v_exp_f32 v54, v54
    v_exp_f32 v55, v55
    v_exp_f32 v56, v56
    v_exp_f32 v57, v57
    v_smfmac_f32_32x32x32_bf16 v[16:31], v[232:235], v[48:55], v5
    v_exp_f32 v58, v58
    v_exp_f32 v59, v59
    v_exp_f32 v60, v60
    v_exp_f32 v61, v61
    v_exp_f32 v62, v62
    v_exp_f32 v63, v63
    v_exp_f32 v32, v32
    v_exp_f32 v33, v33
    v_smfmac_f32_32x32x32_bf16 v[16:31], v[236:239], v[56:63], v5
    v_exp_f32 v34, v34
    v_exp_f32 v35, v35
    v_exp_f32 v36, v36
    v_mfma_f32_32x32x16_bf16 v[48:63], v[124:127], v[8:11], 0
    ds_read_b128 v[8:11], v1 offset:3072
    v_exp_f32 v37, v37
    v_exp_f32 v38, v38
    v_exp_f32 v39, v39
    v_exp_f32 v40, v40
    v_exp_f32 v41, v41
    v_smfmac_f32_32x32x32_bf16 v[16:31], v[240:243], v[32:39], v5
    v_exp_f32 v42, v42
    v_exp_f32 v43, v43
    v_exp_f32 v44, v44
    v_exp_f32 v45, v45
    v_exp_f32 v46, v46
    v_exp_f32 v47, v47
    v_exp_f32 v48, v48
    v_exp_f32 v49, v49
    v_smfmac_f32_32x32x32_bf16 v[16:31], v[244:247], v[40:47], v5
    v_exp_f32 v50, v50
    v_exp_f32 v51, v51
    v_exp_f32 v52, v52
    s_waitcnt lgkmcnt(0)
    v_mfma_f32_32x32x16_bf16 v[32:47], v[64:67], v[8:11], 0
    v_exp_f32 v53, v53
    v_exp_f32 v54, v54
    v_exp_f32 v55, v55
    v_exp_f32 v56, v56
    v_exp_f32 v57, v57
    v_smfmac_f32_32x32x32_bf16 v[16:31], v[248:251], v[48:55], v5
    v_exp_f32 v58, v58
    v_exp_f32 v59, v59
    v_exp_f32 v60, v60
    v_exp_f32 v61, v61
    v_exp_f32 v62, v62
    v_exp_f32 v63, v63
    v_exp_f32 v32, v32
    v_exp_f32 v33, v33
    v_smfmac_f32_32x32x32_bf16 v[16:31], v[252:255], v[56:63], v5
    v_exp_f32 v34, v34
    v_exp_f32 v35, v35
    v_exp_f32 v36, v36
    v_mfma_f32_32x32x16_bf16 v[48:63], v[68:71], v[8:11], 0
    v_exp_f32 v37, v37
    v_exp_f32 v38, v38
    v_exp_f32 v39, v39
    v_exp_f32 v40, v40
    v_exp_f32 v41, v41
    v_exp_f32 v42, v42
    v_exp_f32 v43, v43
    v_exp_f32 v44, v44
    ds_write_addtid_b32 v16 offset:13312
    ds_write_addtid_b32 v17 offset:13568
    ds_write_addtid_b32 v18 offset:13824
    v_exp_f32 v45, v45
    ds_write_addtid_b32 v19 offset:14080
    ds_write_addtid_b32 v20 offset:14336
    ds_write_addtid_b32 v21 offset:14592
    v_exp_f32 v46, v46
    ds_write_addtid_b32 v22 offset:14848
    ds_write_addtid_b32 v23 offset:15104
    ds_write_addtid_b32 v24 offset:15360
    v_mfma_f32_32x32x8_bf16 v[16:31], v[6:7], v[6:7], 0
    v_exp_f32 v47, v47
    v_exp_f32 v48, v48
    v_exp_f32 v49, v49
    v_exp_f32 v50, v50
    v_smfmac_f32_32x32x32_bf16 v[16:31], v[128:131], v[32:39], v5
    v_exp_f32 v51, v51
    v_exp_f32 v52, v52
    v_exp_f32 v53, v53
    v_smfmac_f32_32x32x32_bf16 v[16:31], v[132:135], v[40:47], v5
    v_exp_f32 v54, v54
    v_exp_f32 v55, v55
    v_exp_f32 v56, v56
    v_mfma_f32_32x32x16_bf16 v[32:47], v[72:75], v[8:11], 0
    ds_write_addtid_b32 v5 offset:15616
    v_exp_f32 v57, v57
    v_exp_f32 v58, v58
    v_exp_f32 v59, v59
    v_smfmac_f32_32x32x32_bf16 v[16:31], v[136:139], v[48:55], v5
    v_exp_f32 v60, v60
    v_exp_f32 v61, v61
    v_exp_f32 v62, v62
    v_exp_f32 v63, v63
    s_nop 2
    v_exp_f32 v32, v32
    v_exp_f32 v33, v33
    v_smfmac_f32_32x32x32_bf16 v[16:31], v[140:143], v[56:63], v5
    v_exp_f32 v34, v34
    v_exp_f32 v35, v35
    v_exp_f32 v36, v36
    v_mfma_f32_32x32x16_bf16 v[48:63], v[76:79], v[8:11], 0
    v_exp_f32 v37, v37
    v_exp_f32 v38, v38
    v_exp_f32 v39, v39
    v_exp_f32 v40, v40
    v_exp_f32 v41, v41
    v_smfmac_f32_32x32x32_bf16 v[16:31], v[144:147], v[32:39], v5
    v_exp_f32 v42, v42
    v_exp_f32 v43, v43
    v_exp_f32 v44, v44
    v_exp_f32 v45, v45
    v_exp_f32 v46, v46
    v_exp_f32 v47, v47
    v_exp_f32 v48, v48
    v_exp_f32 v49, v49
    v_smfmac_f32_32x32x32_bf16 v[16:31], v[148:151], v[40:47], v5
    v_exp_f32 v50, v50
    v_exp_f32 v51, v51
    v_exp_f32 v52, v52
    v_mfma_f32_32x32x16_bf16 v[32:47], v[80:83], v[8:11], 0
    v_exp_f32 v53, v53
    v_exp_f32 v54, v54
    v_exp_f32 v55, v55
    v_exp_f32 v56, v56
    v_exp_f32 v57, v57
    v_smfmac_f32_32x32x32_bf16 v[16:31], v[152:155], v[48:55], v5
    v_exp_f32 v58, v58
    v_exp_f32 v59, v59
    v_exp_f32 v60, v60
    v_exp_f32 v61, v61
    v_exp_f32 v62, v62
    v_exp_f32 v63, v63
    v_exp_f32 v32, v32
    v_exp_f32 v33, v33
    v_smfmac_f32_32x32x32_bf16 v[16:31], v[156:159], v[56:63], v5
    v_exp_f32 v34, v34
    v_exp_f32 v35, v35
    v_exp_f32 v36, v36
    v_mfma_f32_32x32x16_bf16 v[48:63], v[84:87], v[8:11], 0
    v_exp_f32 v37, v37
    v_exp_f32 v38, v38
    v_exp_f32 v39, v39
    v_exp_f32 v40, v40
    v_exp_f32 v41, v41
    v_smfmac_f32_32x32x32_bf16 v[16:31], v[160:163], v[32:39], v5
    v_exp_f32 v42, v42
    v_exp_f32 v43, v43
    v_exp_f32 v44, v44
    v_exp_f32 v45, v45
    v_exp_f32 v46, v46
    v_exp_f32 v47, v47
    v_exp_f32 v48, v48
    v_exp_f32 v49, v49
    v_smfmac_f32_32x32x32_bf16 v[16:31], v[164:167], v[40:47], v5
    v_exp_f32 v50, v50
    v_exp_f32 v51, v51
    v_exp_f32 v52, v52
    v_mfma_f32_32x32x16_bf16 v[32:47], v[88:91], v[8:11], 0
    v_exp_f32 v53, v53
    v_exp_f32 v54, v54
    v_exp_f32 v55, v55
    v_exp_f32 v56, v56
    v_exp_f32 v57, v57
    v_smfmac_f32_32x32x32_bf16 v[16:31], v[168:171], v[48:55], v5
    v_exp_f32 v58, v58
    v_exp_f32 v59, v59
    v_exp_f32 v60, v60
    v_exp_f32 v61, v61
    v_exp_f32 v62, v62
    v_exp_f32 v63, v63
    v_exp_f32 v32, v32
    v_exp_f32 v33, v33
    v_smfmac_f32_32x32x32_bf16 v[16:31], v[172:175], v[56:63], v5
    v_exp_f32 v34, v34
    v_exp_f32 v35, v35
    v_exp_f32 v36, v36
    v_mfma_f32_32x32x16_bf16 v[48:63], v[92:95], v[8:11], 0
    v_exp_f32 v37, v37
    v_exp_f32 v38, v38
    v_exp_f32 v39, v39
    v_exp_f32 v40, v40
    v_exp_f32 v41, v41
    v_smfmac_f32_32x32x32_bf16 v[16:31], v[176:179], v[32:39], v5
    v_exp_f32 v42, v42
    v_exp_f32 v43, v43
    v_exp_f32 v44, v44
    v_exp_f32 v45, v45
    v_exp_f32 v46, v46
    v_exp_f32 v47, v47
    v_exp_f32 v48, v48
    v_exp_f32 v49, v49
    v_smfmac_f32_32x32x32_bf16 v[16:31], v[180:183], v[40:47], v5
    v_exp_f32 v50, v50
    v_exp_f32 v51, v51
    v_exp_f32 v52, v52
    v_mfma_f32_32x32x16_bf16 v[32:47], v[96:99], v[8:11], 0
    v_exp_f32 v53, v53
    v_exp_f32 v54, v54
    v_exp_f32 v55, v55
    v_exp_f32 v56, v56
    v_exp_f32 v57, v57
    v_smfmac_f32_32x32x32_bf16 v[16:31], v[184:187], v[48:55], v5
    v_exp_f32 v58, v58
    v_exp_f32 v59, v59
    v_exp_f32 v60, v60
    v_exp_f32 v61, v61
    v_exp_f32 v62, v62
    v_exp_f32 v63, v63
    v_exp_f32 v32, v32
    v_exp_f32 v33, v33
    v_smfmac_f32_32x32x32_bf16 v[16:31], v[188:191], v[56:63], v5
    v_exp_f32 v34, v34
    v_exp_f32 v35, v35
    v_exp_f32 v36, v36
    v_mfma_f32_32x32x16_bf16 v[48:63], v[100:103], v[8:11], 0
    v_exp_f32 v37, v37
    v_exp_f32 v38, v38
    v_exp_f32 v39, v39
    v_exp_f32 v40, v40
    v_exp_f32 v41, v41
    v_smfmac_f32_32x32x32_bf16 v[16:31], v[192:195], v[32:39], v5
    v_exp_f32 v42, v42
    v_exp_f32 v43, v43
    v_exp_f32 v44, v44
    v_exp_f32 v45, v45
    v_exp_f32 v46, v46
    v_exp_f32 v47, v47
    v_exp_f32 v48, v48
    v_exp_f32 v49, v49
    v_smfmac_f32_32x32x32_bf16 v[16:31], v[196:199], v[40:47], v5
    v_exp_f32 v50, v50
    v_exp_f32 v51, v51
    v_exp_f32 v52, v52
    v_mfma_f32_32x32x16_bf16 v[32:47], v[104:107], v[8:11], 0
    v_exp_f32 v53, v53
    v_exp_f32 v54, v54
    v_exp_f32 v55, v55
    v_exp_f32 v56, v56
    v_exp_f32 v57, v57
    v_smfmac_f32_32x32x32_bf16 v[16:31], v[200:203], v[48:55], v5
    v_exp_f32 v58, v58
    v_exp_f32 v59, v59
    v_exp_f32 v60, v60
    v_exp_f32 v61, v61
    v_exp_f32 v62, v62
    v_exp_f32 v63, v63
    v_exp_f32 v32, v32
    v_exp_f32 v33, v33
    v_smfmac_f32_32x32x32_bf16 v[16:31], v[204:207], v[56:63], v5
    v_exp_f32 v34, v34
    v_exp_f32 v35, v35
    v_exp_f32 v36, v36
    v_mfma_f32_32x32x16_bf16 v[48:63], v[108:111], v[8:11], 0
    v_exp_f32 v37, v37
    v_exp_f32 v38, v38
    v_exp_f32 v39, v39
    v_exp_f32 v40, v40
    v_exp_f32 v41, v41
    v_smfmac_f32_32x32x32_bf16 v[16:31], v[208:211], v[32:39], v5
    v_exp_f32 v42, v42
    v_exp_f32 v43, v43
    v_exp_f32 v44, v44
    v_exp_f32 v45, v45
    v_exp_f32 v46, v46
    v_exp_f32 v47, v47
    v_exp_f32 v48, v48
    v_exp_f32 v49, v49
    v_smfmac_f32_32x32x32_bf16 v[16:31], v[212:215], v[40:47], v5
    v_exp_f32 v50, v50
    v_exp_f32 v51, v51
    v_exp_f32 v52, v52
    v_mfma_f32_32x32x16_bf16 v[32:47], v[112:115], v[8:11], 0
    v_exp_f32 v53, v53
    v_exp_f32 v54, v54
    v_exp_f32 v55, v55
    v_exp_f32 v56, v56
    v_exp_f32 v57, v57
    v_smfmac_f32_32x32x32_bf16 v[16:31], v[216:219], v[48:55], v5
    v_exp_f32 v58, v58
    v_exp_f32 v59, v59
    v_exp_f32 v60, v60
    v_exp_f32 v61, v61
    v_exp_f32 v62, v62
    v_exp_f32 v63, v63
    v_exp_f32 v32, v32
    v_exp_f32 v33, v33
    v_smfmac_f32_32x32x32_bf16 v[16:31], v[220:223], v[56:63], v5
    v_exp_f32 v34, v34
    v_exp_f32 v35, v35
    v_exp_f32 v36, v36
    v_mfma_f32_32x32x16_bf16 v[48:63], v[116:119], v[8:11], 0
    v_exp_f32 v37, v37
    v_exp_f32 v38, v38
    v_exp_f32 v39, v39
    v_exp_f32 v40, v40
    v_exp_f32 v41, v41
    v_smfmac_f32_32x32x32_bf16 v[16:31], v[224:227], v[32:39], v5
    v_exp_f32 v42, v42
    v_exp_f32 v43, v43
    v_exp_f32 v44, v44
    v_exp_f32 v45, v45
    v_exp_f32 v46, v46
    v_exp_f32 v47, v47
    v_exp_f32 v48, v48
    v_exp_f32 v49, v49
    v_smfmac_f32_32x32x32_bf16 v[16:31], v[228:231], v[40:47], v5
    v_exp_f32 v50, v50
    v_exp_f32 v51, v51
    v_exp_f32 v52, v52
    v_mfma_f32_32x32x16_bf16 v[32:47], v[120:123], v[8:11], 0
    v_exp_f32 v53, v53
    v_exp_f32 v54, v54
    v_exp_f32 v55, v55
    v_exp_f32 v56, v56
    v_exp_f32 v57, v57
    v_smfmac_f32_32x32x32_bf16 v[16:31], v[232:235], v[48:55], v5
    v_exp_f32 v58, v58
    v_exp_f32 v59, v59
    v_exp_f32 v60, v60
    v_exp_f32 v61, v61
    v_exp_f32 v62, v62
    v_exp_f32 v63, v63
    v_exp_f32 v32, v32
    v_exp_f32 v33, v33
    v_smfmac_f32_32x32x32_bf16 v[16:31], v[236:239], v[56:63], v5
    v_exp_f32 v34, v34
    v_exp_f32 v35, v35
    v_exp_f32 v36, v36
    v_mfma_f32_32x32x16_bf16 v[48:63], v[124:127], v[8:11], 0
    ds_read_b128 v[8:11], v1 offset:4096
    v_exp_f32 v37, v37
    v_exp_f32 v38, v38
    v_exp_f32 v39, v39
    v_exp_f32 v40, v40
    v_exp_f32 v41, v41
    v_smfmac_f32_32x32x32_bf16 v[16:31], v[240:243], v[32:39], v5
    v_exp_f32 v42, v42
    v_exp_f32 v43, v43
    v_exp_f32 v44, v44
    v_exp_f32 v45, v45
    v_exp_f32 v46, v46
    v_exp_f32 v47, v47
    v_exp_f32 v48, v48
    v_exp_f32 v49, v49
    v_smfmac_f32_32x32x32_bf16 v[16:31], v[244:247], v[40:47], v5
    v_exp_f32 v50, v50
    v_exp_f32 v51, v51
    v_exp_f32 v52, v52
    s_waitcnt lgkmcnt(0)
    v_mfma_f32_32x32x16_bf16 v[32:47], v[64:67], v[8:11], 0
    v_exp_f32 v53, v53
    v_exp_f32 v54, v54
    v_exp_f32 v55, v55
    v_exp_f32 v56, v56
    v_exp_f32 v57, v57
    v_smfmac_f32_32x32x32_bf16 v[16:31], v[248:251], v[48:55], v5
    v_exp_f32 v58, v58
    v_exp_f32 v59, v59
    v_exp_f32 v60, v60
    v_exp_f32 v61, v61
    v_exp_f32 v62, v62
    v_exp_f32 v63, v63
    v_exp_f32 v32, v32
    v_exp_f32 v33, v33
    v_smfmac_f32_32x32x32_bf16 v[16:31], v[252:255], v[56:63], v5
    v_exp_f32 v34, v34
    v_exp_f32 v35, v35
    v_exp_f32 v36, v36
    v_mfma_f32_32x32x16_bf16 v[48:63], v[68:71], v[8:11], 0
    v_exp_f32 v37, v37
    v_exp_f32 v38, v38
    v_exp_f32 v39, v39
    v_exp_f32 v40, v40
    v_exp_f32 v41, v41
    v_exp_f32 v42, v42
    v_exp_f32 v43, v43
    v_exp_f32 v44, v44
    ds_write_addtid_b32 v16 offset:15872
    ds_write_addtid_b32 v17 offset:16128
    ds_write_addtid_b32 v18 offset:16384
    v_exp_f32 v45, v45
    ds_write_addtid_b32 v19 offset:16640
    ds_write_addtid_b32 v20 offset:16896
    ds_write_addtid_b32 v21 offset:17152
    v_exp_f32 v46, v46
    ds_write_addtid_b32 v22 offset:17408
    ds_write_addtid_b32 v23 offset:17664
    ds_write_addtid_b32 v24 offset:17920
    v_mfma_f32_32x32x8_bf16 v[16:31], v[6:7], v[6:7], 0
    v_exp_f32 v47, v47
    v_exp_f32 v48, v48
    v_exp_f32 v49, v49
    v_exp_f32 v50, v50
    v_smfmac_f32_32x32x32_bf16 v[16:31], v[128:131], v[32:39], v5
    v_exp_f32 v51, v51
    v_exp_f32 v52, v52
    v_exp_f32 v53, v53
    v_smfmac_f32_32x32x32_bf16 v[16:31], v[132:135], v[40:47], v5
    v_exp_f32 v54, v54
    v_exp_f32 v55, v55
    v_exp_f32 v56, v56
    v_mfma_f32_32x32x16_bf16 v[32:47], v[72:75], v[8:11], 0
    ds_write_addtid_b32 v5 offset:18176
    v_exp_f32 v57, v57
    v_exp_f32 v58, v58
    v_exp_f32 v59, v59
    v_smfmac_f32_32x32x32_bf16 v[16:31], v[136:139], v[48:55], v5
    v_exp_f32 v60, v60
    v_exp_f32 v61, v61
    v_exp_f32 v62, v62
    v_exp_f32 v63, v63
    s_nop 2
    v_exp_f32 v32, v32
    v_exp_f32 v33, v33
    v_smfmac_f32_32x32x32_bf16 v[16:31], v[140:143], v[56:63], v5
    v_exp_f32 v34, v34
    v_exp_f32 v35, v35
    v_exp_f32 v36, v36
    v_mfma_f32_32x32x16_bf16 v[48:63], v[76:79], v[8:11], 0
    v_exp_f32 v37, v37
    v_exp_f32 v38, v38
    v_exp_f32 v39, v39
    v_exp_f32 v40, v40
    v_exp_f32 v41, v41
    v_smfmac_f32_32x32x32_bf16 v[16:31], v[144:147], v[32:39], v5
    v_exp_f32 v42, v42
    v_exp_f32 v43, v43
    v_exp_f32 v44, v44
    v_exp_f32 v45, v45
    v_exp_f32 v46, v46
    v_exp_f32 v47, v47
    v_exp_f32 v48, v48
    v_exp_f32 v49, v49
    v_smfmac_f32_32x32x32_bf16 v[16:31], v[148:151], v[40:47], v5
    v_exp_f32 v50, v50
    v_exp_f32 v51, v51
    v_exp_f32 v52, v52
    v_mfma_f32_32x32x16_bf16 v[32:47], v[80:83], v[8:11], 0
    v_exp_f32 v53, v53
    v_exp_f32 v54, v54
    v_exp_f32 v55, v55
    v_exp_f32 v56, v56
    v_exp_f32 v57, v57
    v_smfmac_f32_32x32x32_bf16 v[16:31], v[152:155], v[48:55], v5
    v_exp_f32 v58, v58
    v_exp_f32 v59, v59
    v_exp_f32 v60, v60
    v_exp_f32 v61, v61
    v_exp_f32 v62, v62
    v_exp_f32 v63, v63
    v_exp_f32 v32, v32
    v_exp_f32 v33, v33
    v_smfmac_f32_32x32x32_bf16 v[16:31], v[156:159], v[56:63], v5
    v_exp_f32 v34, v34
    v_exp_f32 v35, v35
    v_exp_f32 v36, v36
    v_mfma_f32_32x32x16_bf16 v[48:63], v[84:87], v[8:11], 0
    v_exp_f32 v37, v37
    v_exp_f32 v38, v38
    v_exp_f32 v39, v39
    v_exp_f32 v40, v40
    v_exp_f32 v41, v41
    v_smfmac_f32_32x32x32_bf16 v[16:31], v[160:163], v[32:39], v5
    v_exp_f32 v42, v42
    v_exp_f32 v43, v43
    v_exp_f32 v44, v44
    v_exp_f32 v45, v45
    v_exp_f32 v46, v46
    v_exp_f32 v47, v47
    v_exp_f32 v48, v48
    v_exp_f32 v49, v49
    v_smfmac_f32_32x32x32_bf16 v[16:31], v[164:167], v[40:47], v5
    v_exp_f32 v50, v50
    v_exp_f32 v51, v51
    v_exp_f32 v52, v52
    v_mfma_f32_32x32x16_bf16 v[32:47], v[88:91], v[8:11], 0
    v_exp_f32 v53, v53
    v_exp_f32 v54, v54
    v_exp_f32 v55, v55
    v_exp_f32 v56, v56
    v_exp_f32 v57, v57
    v_smfmac_f32_32x32x32_bf16 v[16:31], v[168:171], v[48:55], v5
    v_exp_f32 v58, v58
    v_exp_f32 v59, v59
    v_exp_f32 v60, v60
    v_exp_f32 v61, v61
    v_exp_f32 v62, v62
    v_exp_f32 v63, v63
    v_exp_f32 v32, v32
    v_exp_f32 v33, v33
    v_smfmac_f32_32x32x32_bf16 v[16:31], v[172:175], v[56:63], v5
    v_exp_f32 v34, v34
    v_exp_f32 v35, v35
    v_exp_f32 v36, v36
    v_mfma_f32_32x32x16_bf16 v[48:63], v[92:95], v[8:11], 0
    v_exp_f32 v37, v37
    v_exp_f32 v38, v38
    v_exp_f32 v39, v39
    v_exp_f32 v40, v40
    v_exp_f32 v41, v41
    v_smfmac_f32_32x32x32_bf16 v[16:31], v[176:179], v[32:39], v5
    v_exp_f32 v42, v42
    v_exp_f32 v43, v43
    v_exp_f32 v44, v44
    v_exp_f32 v45, v45
    v_exp_f32 v46, v46
    v_exp_f32 v47, v47
    v_exp_f32 v48, v48
    v_exp_f32 v49, v49
    v_smfmac_f32_32x32x32_bf16 v[16:31], v[180:183], v[40:47], v5
    v_exp_f32 v50, v50
    v_exp_f32 v51, v51
    v_exp_f32 v52, v52
    v_mfma_f32_32x32x16_bf16 v[32:47], v[96:99], v[8:11], 0
    v_exp_f32 v53, v53
    v_exp_f32 v54, v54
    v_exp_f32 v55, v55
    v_exp_f32 v56, v56
    v_exp_f32 v57, v57
    v_smfmac_f32_32x32x32_bf16 v[16:31], v[184:187], v[48:55], v5
    v_exp_f32 v58, v58
    v_exp_f32 v59, v59
    v_exp_f32 v60, v60
    v_exp_f32 v61, v61
    v_exp_f32 v62, v62
    v_exp_f32 v63, v63
    v_exp_f32 v32, v32
    v_exp_f32 v33, v33
    v_smfmac_f32_32x32x32_bf16 v[16:31], v[188:191], v[56:63], v5
    v_exp_f32 v34, v34
    v_exp_f32 v35, v35
    v_exp_f32 v36, v36
    v_mfma_f32_32x32x16_bf16 v[48:63], v[100:103], v[8:11], 0
    v_exp_f32 v37, v37
    v_exp_f32 v38, v38
    v_exp_f32 v39, v39
    v_exp_f32 v40, v40
    v_exp_f32 v41, v41
    v_smfmac_f32_32x32x32_bf16 v[16:31], v[192:195], v[32:39], v5
    v_exp_f32 v42, v42
    v_exp_f32 v43, v43
    v_exp_f32 v44, v44
    v_exp_f32 v45, v45
    v_exp_f32 v46, v46
    v_exp_f32 v47, v47
    v_exp_f32 v48, v48
    v_exp_f32 v49, v49
    v_smfmac_f32_32x32x32_bf16 v[16:31], v[196:199], v[40:47], v5
    v_exp_f32 v50, v50
    v_exp_f32 v51, v51
    v_exp_f32 v52, v52
    v_mfma_f32_32x32x16_bf16 v[32:47], v[104:107], v[8:11], 0
    v_exp_f32 v53, v53
    v_exp_f32 v54, v54
    v_exp_f32 v55, v55
    v_exp_f32 v56, v56
    v_exp_f32 v57, v57
    v_smfmac_f32_32x32x32_bf16 v[16:31], v[200:203], v[48:55], v5
    v_exp_f32 v58, v58
    v_exp_f32 v59, v59
    v_exp_f32 v60, v60
    v_exp_f32 v61, v61
    v_exp_f32 v62, v62
    v_exp_f32 v63, v63
    v_exp_f32 v32, v32
    v_exp_f32 v33, v33
    v_smfmac_f32_32x32x32_bf16 v[16:31], v[204:207], v[56:63], v5
    v_exp_f32 v34, v34
    v_exp_f32 v35, v35
    v_exp_f32 v36, v36
    v_mfma_f32_32x32x16_bf16 v[48:63], v[108:111], v[8:11], 0
    v_exp_f32 v37, v37
    v_exp_f32 v38, v38
    v_exp_f32 v39, v39
    v_exp_f32 v40, v40
    v_exp_f32 v41, v41
    v_smfmac_f32_32x32x32_bf16 v[16:31], v[208:211], v[32:39], v5
    v_exp_f32 v42, v42
    v_exp_f32 v43, v43
    v_exp_f32 v44, v44
    v_exp_f32 v45, v45
    v_exp_f32 v46, v46
    v_exp_f32 v47, v47
    v_exp_f32 v48, v48
    v_exp_f32 v49, v49
    v_smfmac_f32_32x32x32_bf16 v[16:31], v[212:215], v[40:47], v5
    v_exp_f32 v50, v50
    v_exp_f32 v51, v51
    v_exp_f32 v52, v52
    v_mfma_f32_32x32x16_bf16 v[32:47], v[112:115], v[8:11], 0
    v_exp_f32 v53, v53
    v_exp_f32 v54, v54
    v_exp_f32 v55, v55
    v_exp_f32 v56, v56
    v_exp_f32 v57, v57
    v_smfmac_f32_32x32x32_bf16 v[16:31], v[216:219], v[48:55], v5
    v_exp_f32 v58, v58
    v_exp_f32 v59, v59
    v_exp_f32 v60, v60
    v_exp_f32 v61, v61
    v_exp_f32 v62, v62
    v_exp_f32 v63, v63
    v_exp_f32 v32, v32
    v_exp_f32 v33, v33
    v_smfmac_f32_32x32x32_bf16 v[16:31], v[220:223], v[56:63], v5
    v_exp_f32 v34, v34
    v_exp_f32 v35, v35
    v_exp_f32 v36, v36
    v_mfma_f32_32x32x16_bf16 v[48:63], v[116:119], v[8:11], 0
    v_exp_f32 v37, v37
    v_exp_f32 v38, v38
    v_exp_f32 v39, v39
    v_exp_f32 v40, v40
    v_exp_f32 v41, v41
    v_smfmac_f32_32x32x32_bf16 v[16:31], v[224:227], v[32:39], v5
    v_exp_f32 v42, v42
    v_exp_f32 v43, v43
    v_exp_f32 v44, v44
    v_exp_f32 v45, v45
    v_exp_f32 v46, v46
    v_exp_f32 v47, v47
    v_exp_f32 v48, v48
    v_exp_f32 v49, v49
    v_smfmac_f32_32x32x32_bf16 v[16:31], v[228:231], v[40:47], v5
    v_exp_f32 v50, v50
    v_exp_f32 v51, v51
    v_exp_f32 v52, v52
    v_mfma_f32_32x32x16_bf16 v[32:47], v[120:123], v[8:11], 0
    v_exp_f32 v53, v53
    v_exp_f32 v54, v54
    v_exp_f32 v55, v55
    v_exp_f32 v56, v56
    v_exp_f32 v57, v57
    v_smfmac_f32_32x32x32_bf16 v[16:31], v[232:235], v[48:55], v5
    v_exp_f32 v58, v58
    v_exp_f32 v59, v59
    v_exp_f32 v60, v60
    v_exp_f32 v61, v61
    v_exp_f32 v62, v62
    v_exp_f32 v63, v63
    v_exp_f32 v32, v32
    v_exp_f32 v33, v33
    v_smfmac_f32_32x32x32_bf16 v[16:31], v[236:239], v[56:63], v5
    v_exp_f32 v34, v34
    v_exp_f32 v35, v35
    v_exp_f32 v36, v36
    v_mfma_f32_32x32x16_bf16 v[48:63], v[124:127], v[8:11], 0
    ds_read_b128 v[8:11], v1 offset:5120
    v_exp_f32 v37, v37
    v_exp_f32 v38, v38
    v_exp_f32 v39, v39
    v_exp_f32 v40, v40
    v_exp_f32 v41, v41
    v_smfmac_f32_32x32x32_bf16 v[16:31], v[240:243], v[32:39], v5
    v_exp_f32 v42, v42
    v_exp_f32 v43, v43
    v_exp_f32 v44, v44
    v_exp_f32 v45, v45
    v_exp_f32 v46, v46
    v_exp_f32 v47, v47
    v_exp_f32 v48, v48
    v_exp_f32 v49, v49
    v_smfmac_f32_32x32x32_bf16 v[16:31], v[244:247], v[40:47], v5
    v_exp_f32 v50, v50
    v_exp_f32 v51, v51
    v_exp_f32 v52, v52
    s_waitcnt lgkmcnt(0)
    v_mfma_f32_32x32x16_bf16 v[32:47], v[64:67], v[8:11], 0
    v_exp_f32 v53, v53
    v_exp_f32 v54, v54
    v_exp_f32 v55, v55
    v_exp_f32 v56, v56
    v_exp_f32 v57, v57
    v_smfmac_f32_32x32x32_bf16 v[16:31], v[248:251], v[48:55], v5
    v_exp_f32 v58, v58
    v_exp_f32 v59, v59
    v_exp_f32 v60, v60
    v_exp_f32 v61, v61
    v_exp_f32 v62, v62
    v_exp_f32 v63, v63
    v_exp_f32 v32, v32
    v_exp_f32 v33, v33
    v_smfmac_f32_32x32x32_bf16 v[16:31], v[252:255], v[56:63], v5
    v_exp_f32 v34, v34
    v_exp_f32 v35, v35
    v_exp_f32 v36, v36
    v_mfma_f32_32x32x16_bf16 v[48:63], v[68:71], v[8:11], 0
    v_exp_f32 v37, v37
    v_exp_f32 v38, v38
    v_exp_f32 v39, v39
    v_exp_f32 v40, v40
    v_exp_f32 v41, v41
    v_exp_f32 v42, v42
    v_exp_f32 v43, v43
    v_exp_f32 v44, v44
    ds_write_addtid_b32 v16 offset:18432
    ds_write_addtid_b32 v17 offset:18688
    ds_write_addtid_b32 v18 offset:18944
    v_exp_f32 v45, v45
    ds_write_addtid_b32 v19 offset:19200
    ds_write_addtid_b32 v20 offset:19456
    ds_write_addtid_b32 v21 offset:19712
    v_exp_f32 v46, v46
    ds_write_addtid_b32 v22 offset:19968
    ds_write_addtid_b32 v23 offset:20224
    ds_write_addtid_b32 v24 offset:20480
    v_mfma_f32_32x32x8_bf16 v[16:31], v[6:7], v[6:7], 0
    v_exp_f32 v47, v47
    v_exp_f32 v48, v48
    v_exp_f32 v49, v49
    v_exp_f32 v50, v50
    v_smfmac_f32_32x32x32_bf16 v[16:31], v[128:131], v[32:39], v5
    v_exp_f32 v51, v51
    v_exp_f32 v52, v52
    v_exp_f32 v53, v53
    v_smfmac_f32_32x32x32_bf16 v[16:31], v[132:135], v[40:47], v5
    v_exp_f32 v54, v54
    v_exp_f32 v55, v55
    v_exp_f32 v56, v56
    v_mfma_f32_32x32x16_bf16 v[32:47], v[72:75], v[8:11], 0
    ds_write_addtid_b32 v5 offset:20736
    v_exp_f32 v57, v57
    v_exp_f32 v58, v58
    v_exp_f32 v59, v59
    v_smfmac_f32_32x32x32_bf16 v[16:31], v[136:139], v[48:55], v5
    v_exp_f32 v60, v60
    v_exp_f32 v61, v61
    v_exp_f32 v62, v62
    v_exp_f32 v63, v63
    s_nop 2
    v_exp_f32 v32, v32
    v_exp_f32 v33, v33
    v_smfmac_f32_32x32x32_bf16 v[16:31], v[140:143], v[56:63], v5
    v_exp_f32 v34, v34
    v_exp_f32 v35, v35
    v_exp_f32 v36, v36
    v_mfma_f32_32x32x16_bf16 v[48:63], v[76:79], v[8:11], 0
    v_exp_f32 v37, v37
    v_exp_f32 v38, v38
    v_exp_f32 v39, v39
    v_exp_f32 v40, v40
    v_exp_f32 v41, v41
    v_smfmac_f32_32x32x32_bf16 v[16:31], v[144:147], v[32:39], v5
    v_exp_f32 v42, v42
    v_exp_f32 v43, v43
    v_exp_f32 v44, v44
    v_exp_f32 v45, v45
    v_exp_f32 v46, v46
    v_exp_f32 v47, v47
    v_exp_f32 v48, v48
    v_exp_f32 v49, v49
    v_smfmac_f32_32x32x32_bf16 v[16:31], v[148:151], v[40:47], v5
    v_exp_f32 v50, v50
    v_exp_f32 v51, v51
    v_exp_f32 v52, v52
    v_mfma_f32_32x32x16_bf16 v[32:47], v[80:83], v[8:11], 0
    v_exp_f32 v53, v53
    v_exp_f32 v54, v54
    v_exp_f32 v55, v55
    v_exp_f32 v56, v56
    v_exp_f32 v57, v57
    v_smfmac_f32_32x32x32_bf16 v[16:31], v[152:155], v[48:55], v5
    v_exp_f32 v58, v58
    v_exp_f32 v59, v59
    v_exp_f32 v60, v60
    v_exp_f32 v61, v61
    v_exp_f32 v62, v62
    v_exp_f32 v63, v63
    v_exp_f32 v32, v32
    v_exp_f32 v33, v33
    v_smfmac_f32_32x32x32_bf16 v[16:31], v[156:159], v[56:63], v5
    v_exp_f32 v34, v34
    v_exp_f32 v35, v35
    v_exp_f32 v36, v36
    v_mfma_f32_32x32x16_bf16 v[48:63], v[84:87], v[8:11], 0
    v_exp_f32 v37, v37
    v_exp_f32 v38, v38
    v_exp_f32 v39, v39
    v_exp_f32 v40, v40
    v_exp_f32 v41, v41
    v_smfmac_f32_32x32x32_bf16 v[16:31], v[160:163], v[32:39], v5
    v_exp_f32 v42, v42
    v_exp_f32 v43, v43
    v_exp_f32 v44, v44
    v_exp_f32 v45, v45
    v_exp_f32 v46, v46
    v_exp_f32 v47, v47
    v_exp_f32 v48, v48
    v_exp_f32 v49, v49
    v_smfmac_f32_32x32x32_bf16 v[16:31], v[164:167], v[40:47], v5
    v_exp_f32 v50, v50
    v_exp_f32 v51, v51
    v_exp_f32 v52, v52
    v_mfma_f32_32x32x16_bf16 v[32:47], v[88:91], v[8:11], 0
    v_exp_f32 v53, v53
    v_exp_f32 v54, v54
    v_exp_f32 v55, v55
    v_exp_f32 v56, v56
    v_exp_f32 v57, v57
    v_smfmac_f32_32x32x32_bf16 v[16:31], v[168:171], v[48:55], v5
    v_exp_f32 v58, v58
    v_exp_f32 v59, v59
    v_exp_f32 v60, v60
    v_exp_f32 v61, v61
    v_exp_f32 v62, v62
    v_exp_f32 v63, v63
    v_exp_f32 v32, v32
    v_exp_f32 v33, v33
    v_smfmac_f32_32x32x32_bf16 v[16:31], v[172:175], v[56:63], v5
    v_exp_f32 v34, v34
    v_exp_f32 v35, v35
    v_exp_f32 v36, v36
    v_mfma_f32_32x32x16_bf16 v[48:63], v[92:95], v[8:11], 0
    v_exp_f32 v37, v37
    v_exp_f32 v38, v38
    v_exp_f32 v39, v39
    v_exp_f32 v40, v40
    v_exp_f32 v41, v41
    v_smfmac_f32_32x32x32_bf16 v[16:31], v[176:179], v[32:39], v5
    v_exp_f32 v42, v42
    v_exp_f32 v43, v43
    v_exp_f32 v44, v44
    v_exp_f32 v45, v45
    v_exp_f32 v46, v46
    v_exp_f32 v47, v47
    v_exp_f32 v48, v48
    v_exp_f32 v49, v49
    v_smfmac_f32_32x32x32_bf16 v[16:31], v[180:183], v[40:47], v5
    v_exp_f32 v50, v50
    v_exp_f32 v51, v51
    v_exp_f32 v52, v52
    v_mfma_f32_32x32x16_bf16 v[32:47], v[96:99], v[8:11], 0
    v_exp_f32 v53, v53
    v_exp_f32 v54, v54
    v_exp_f32 v55, v55
    v_exp_f32 v56, v56
    v_exp_f32 v57, v57
    v_smfmac_f32_32x32x32_bf16 v[16:31], v[184:187], v[48:55], v5
    v_exp_f32 v58, v58
    v_exp_f32 v59, v59
    v_exp_f32 v60, v60
    v_exp_f32 v61, v61
    v_exp_f32 v62, v62
    v_exp_f32 v63, v63
    v_exp_f32 v32, v32
    v_exp_f32 v33, v33
    v_smfmac_f32_32x32x32_bf16 v[16:31], v[188:191], v[56:63], v5
    v_exp_f32 v34, v34
    v_exp_f32 v35, v35
    v_exp_f32 v36, v36
    v_mfma_f32_32x32x16_bf16 v[48:63], v[100:103], v[8:11], 0
    v_exp_f32 v37, v37
    v_exp_f32 v38, v38
    v_exp_f32 v39, v39
    v_exp_f32 v40, v40
    v_exp_f32 v41, v41
    v_smfmac_f32_32x32x32_bf16 v[16:31], v[192:195], v[32:39], v5
    v_exp_f32 v42, v42
    v_exp_f32 v43, v43
    v_exp_f32 v44, v44
    v_exp_f32 v45, v45
    v_exp_f32 v46, v46
    v_exp_f32 v47, v47
    v_exp_f32 v48, v48
    v_exp_f32 v49, v49
    v_smfmac_f32_32x32x32_bf16 v[16:31], v[196:199], v[40:47], v5
    v_exp_f32 v50, v50
    v_exp_f32 v51, v51
    v_exp_f32 v52, v52
    v_mfma_f32_32x32x16_bf16 v[32:47], v[104:107], v[8:11], 0
    v_exp_f32 v53, v53
    v_exp_f32 v54, v54
    v_exp_f32 v55, v55
    v_exp_f32 v56, v56
    v_exp_f32 v57, v57
    v_smfmac_f32_32x32x32_bf16 v[16:31], v[200:203], v[48:55], v5
    v_exp_f32 v58, v58
    v_exp_f32 v59, v59
    v_exp_f32 v60, v60
    v_exp_f32 v61, v61
    v_exp_f32 v62, v62
    v_exp_f32 v63, v63
    v_exp_f32 v32, v32
    v_exp_f32 v33, v33
    v_smfmac_f32_32x32x32_bf16 v[16:31], v[204:207], v[56:63], v5
    v_exp_f32 v34, v34
    v_exp_f32 v35, v35
    v_exp_f32 v36, v36
    v_mfma_f32_32x32x16_bf16 v[48:63], v[108:111], v[8:11], 0
    v_exp_f32 v37, v37
    v_exp_f32 v38, v38
    v_exp_f32 v39, v39
    v_exp_f32 v40, v40
    v_exp_f32 v41, v41
    v_smfmac_f32_32x32x32_bf16 v[16:31], v[208:211], v[32:39], v5
    v_exp_f32 v42, v42
    v_exp_f32 v43, v43
    v_exp_f32 v44, v44
    v_exp_f32 v45, v45
    v_exp_f32 v46, v46
    v_exp_f32 v47, v47
    v_exp_f32 v48, v48
    v_exp_f32 v49, v49
    v_smfmac_f32_32x32x32_bf16 v[16:31], v[212:215], v[40:47], v5
    v_exp_f32 v50, v50
    v_exp_f32 v51, v51
    v_exp_f32 v52, v52
    v_mfma_f32_32x32x16_bf16 v[32:47], v[112:115], v[8:11], 0
    v_exp_f32 v53, v53
    v_exp_f32 v54, v54
    v_exp_f32 v55, v55
    v_exp_f32 v56, v56
    v_exp_f32 v57, v57
    v_smfmac_f32_32x32x32_bf16 v[16:31], v[216:219], v[48:55], v5
    v_exp_f32 v58, v58
    v_exp_f32 v59, v59
    v_exp_f32 v60, v60
    v_exp_f32 v61, v61
    v_exp_f32 v62, v62
    v_exp_f32 v63, v63
    v_exp_f32 v32, v32
    v_exp_f32 v33, v33
    v_smfmac_f32_32x32x32_bf16 v[16:31], v[220:223], v[56:63], v5
    v_exp_f32 v34, v34
    v_exp_f32 v35, v35
    v_exp_f32 v36, v36
    v_mfma_f32_32x32x16_bf16 v[48:63], v[116:119], v[8:11], 0
    v_exp_f32 v37, v37
    v_exp_f32 v38, v38
    v_exp_f32 v39, v39
    v_exp_f32 v40, v40
    v_exp_f32 v41, v41
    v_smfmac_f32_32x32x32_bf16 v[16:31], v[224:227], v[32:39], v5
    v_exp_f32 v42, v42
    v_exp_f32 v43, v43
    v_exp_f32 v44, v44
    v_exp_f32 v45, v45
    v_exp_f32 v46, v46
    v_exp_f32 v47, v47
    v_exp_f32 v48, v48
    v_exp_f32 v49, v49
    v_smfmac_f32_32x32x32_bf16 v[16:31], v[228:231], v[40:47], v5
    v_exp_f32 v50, v50
    v_exp_f32 v51, v51
    v_exp_f32 v52, v52
    v_mfma_f32_32x32x16_bf16 v[32:47], v[120:123], v[8:11], 0
    v_exp_f32 v53, v53
    v_exp_f32 v54, v54
    v_exp_f32 v55, v55
    v_exp_f32 v56, v56
    v_exp_f32 v57, v57
    v_smfmac_f32_32x32x32_bf16 v[16:31], v[232:235], v[48:55], v5
    v_exp_f32 v58, v58
    v_exp_f32 v59, v59
    v_exp_f32 v60, v60
    v_exp_f32 v61, v61
    v_exp_f32 v62, v62
    v_exp_f32 v63, v63
    v_exp_f32 v32, v32
    v_exp_f32 v33, v33
    v_smfmac_f32_32x32x32_bf16 v[16:31], v[236:239], v[56:63], v5
    v_exp_f32 v34, v34
    v_exp_f32 v35, v35
    v_exp_f32 v36, v36
    v_mfma_f32_32x32x16_bf16 v[48:63], v[124:127], v[8:11], 0
    ds_read_b128 v[8:11], v1 offset:6144
    v_exp_f32 v37, v37
    v_exp_f32 v38, v38
    v_exp_f32 v39, v39
    v_exp_f32 v40, v40
    v_exp_f32 v41, v41
    v_smfmac_f32_32x32x32_bf16 v[16:31], v[240:243], v[32:39], v5
    v_exp_f32 v42, v42
    v_exp_f32 v43, v43
    v_exp_f32 v44, v44
    v_exp_f32 v45, v45
    v_exp_f32 v46, v46
    v_exp_f32 v47, v47
    v_exp_f32 v48, v48
    v_exp_f32 v49, v49
    v_smfmac_f32_32x32x32_bf16 v[16:31], v[244:247], v[40:47], v5
    v_exp_f32 v50, v50
    v_exp_f32 v51, v51
    v_exp_f32 v52, v52
    s_waitcnt lgkmcnt(0)
    v_mfma_f32_32x32x16_bf16 v[32:47], v[64:67], v[8:11], 0
    v_exp_f32 v53, v53
    v_exp_f32 v54, v54
    v_exp_f32 v55, v55
    v_exp_f32 v56, v56
    v_exp_f32 v57, v57
    v_smfmac_f32_32x32x32_bf16 v[16:31], v[248:251], v[48:55], v5
    v_exp_f32 v58, v58
    v_exp_f32 v59, v59
    v_exp_f32 v60, v60
    v_exp_f32 v61, v61
    v_exp_f32 v62, v62
    v_exp_f32 v63, v63
    v_exp_f32 v32, v32
    v_exp_f32 v33, v33
    v_smfmac_f32_32x32x32_bf16 v[16:31], v[252:255], v[56:63], v5
    v_exp_f32 v34, v34
    v_exp_f32 v35, v35
    v_exp_f32 v36, v36
    v_mfma_f32_32x32x16_bf16 v[48:63], v[68:71], v[8:11], 0
    v_exp_f32 v37, v37
    v_exp_f32 v38, v38
    v_exp_f32 v39, v39
    v_exp_f32 v40, v40
    v_exp_f32 v41, v41
    v_exp_f32 v42, v42
    v_exp_f32 v43, v43
    v_exp_f32 v44, v44
    ds_write_addtid_b32 v16 offset:20992
    ds_write_addtid_b32 v17 offset:21248
    ds_write_addtid_b32 v18 offset:21504
    v_exp_f32 v45, v45
    ds_write_addtid_b32 v19 offset:21760
    ds_write_addtid_b32 v20 offset:22016
    ds_write_addtid_b32 v21 offset:22272
    v_exp_f32 v46, v46
    ds_write_addtid_b32 v22 offset:22528
    ds_write_addtid_b32 v23 offset:22784
    ds_write_addtid_b32 v24 offset:23040
    v_mfma_f32_32x32x8_bf16 v[16:31], v[6:7], v[6:7], 0
    v_exp_f32 v47, v47
    v_exp_f32 v48, v48
    v_exp_f32 v49, v49
    v_exp_f32 v50, v50
    v_smfmac_f32_32x32x32_bf16 v[16:31], v[128:131], v[32:39], v5
    v_exp_f32 v51, v51
    v_exp_f32 v52, v52
    v_exp_f32 v53, v53
    v_smfmac_f32_32x32x32_bf16 v[16:31], v[132:135], v[40:47], v5
    v_exp_f32 v54, v54
    v_exp_f32 v55, v55
    v_exp_f32 v56, v56
    v_mfma_f32_32x32x16_bf16 v[32:47], v[72:75], v[8:11], 0
    ds_write_addtid_b32 v5 offset:23296
    v_exp_f32 v57, v57
    v_exp_f32 v58, v58
    v_exp_f32 v59, v59
    v_smfmac_f32_32x32x32_bf16 v[16:31], v[136:139], v[48:55], v5
    v_exp_f32 v60, v60
    v_exp_f32 v61, v61
    v_exp_f32 v62, v62
    v_exp_f32 v63, v63
    s_nop 2
    v_exp_f32 v32, v32
    v_exp_f32 v33, v33
    v_smfmac_f32_32x32x32_bf16 v[16:31], v[140:143], v[56:63], v5
    v_exp_f32 v34, v34
    v_exp_f32 v35, v35
    v_exp_f32 v36, v36
    v_mfma_f32_32x32x16_bf16 v[48:63], v[76:79], v[8:11], 0
    v_exp_f32 v37, v37
    v_exp_f32 v38, v38
    v_exp_f32 v39, v39
    v_exp_f32 v40, v40
    v_exp_f32 v41, v41
    v_smfmac_f32_32x32x32_bf16 v[16:31], v[144:147], v[32:39], v5
    v_exp_f32 v42, v42
    v_exp_f32 v43, v43
    v_exp_f32 v44, v44
    v_exp_f32 v45, v45
    v_exp_f32 v46, v46
    v_exp_f32 v47, v47
    v_exp_f32 v48, v48
    v_exp_f32 v49, v49
    v_smfmac_f32_32x32x32_bf16 v[16:31], v[148:151], v[40:47], v5
    v_exp_f32 v50, v50
    v_exp_f32 v51, v51
    v_exp_f32 v52, v52
    v_mfma_f32_32x32x16_bf16 v[32:47], v[80:83], v[8:11], 0
    v_exp_f32 v53, v53
    v_exp_f32 v54, v54
    v_exp_f32 v55, v55
    v_exp_f32 v56, v56
    v_exp_f32 v57, v57
    v_smfmac_f32_32x32x32_bf16 v[16:31], v[152:155], v[48:55], v5
    v_exp_f32 v58, v58
    v_exp_f32 v59, v59
    v_exp_f32 v60, v60
    v_exp_f32 v61, v61
    v_exp_f32 v62, v62
    v_exp_f32 v63, v63
    v_exp_f32 v32, v32
    v_exp_f32 v33, v33
    v_smfmac_f32_32x32x32_bf16 v[16:31], v[156:159], v[56:63], v5
    v_exp_f32 v34, v34
    v_exp_f32 v35, v35
    v_exp_f32 v36, v36
    v_mfma_f32_32x32x16_bf16 v[48:63], v[84:87], v[8:11], 0
    v_exp_f32 v37, v37
    v_exp_f32 v38, v38
    v_exp_f32 v39, v39
    v_exp_f32 v40, v40
    v_exp_f32 v41, v41
    v_smfmac_f32_32x32x32_bf16 v[16:31], v[160:163], v[32:39], v5
    v_exp_f32 v42, v42
    v_exp_f32 v43, v43
    v_exp_f32 v44, v44
    v_exp_f32 v45, v45
    v_exp_f32 v46, v46
    v_exp_f32 v47, v47
    v_exp_f32 v48, v48
    v_exp_f32 v49, v49
    v_smfmac_f32_32x32x32_bf16 v[16:31], v[164:167], v[40:47], v5
    v_exp_f32 v50, v50
    v_exp_f32 v51, v51
    v_exp_f32 v52, v52
    v_mfma_f32_32x32x16_bf16 v[32:47], v[88:91], v[8:11], 0
    v_exp_f32 v53, v53
    v_exp_f32 v54, v54
    v_exp_f32 v55, v55
    v_exp_f32 v56, v56
    v_exp_f32 v57, v57
    v_smfmac_f32_32x32x32_bf16 v[16:31], v[168:171], v[48:55], v5
    v_exp_f32 v58, v58
    v_exp_f32 v59, v59
    v_exp_f32 v60, v60
    v_exp_f32 v61, v61
    v_exp_f32 v62, v62
    v_exp_f32 v63, v63
    v_exp_f32 v32, v32
    v_exp_f32 v33, v33
    v_smfmac_f32_32x32x32_bf16 v[16:31], v[172:175], v[56:63], v5
    v_exp_f32 v34, v34
    v_exp_f32 v35, v35
    v_exp_f32 v36, v36
    v_mfma_f32_32x32x16_bf16 v[48:63], v[92:95], v[8:11], 0
    v_exp_f32 v37, v37
    v_exp_f32 v38, v38
    v_exp_f32 v39, v39
    v_exp_f32 v40, v40
    v_exp_f32 v41, v41
    v_smfmac_f32_32x32x32_bf16 v[16:31], v[176:179], v[32:39], v5
    v_exp_f32 v42, v42
    v_exp_f32 v43, v43
    v_exp_f32 v44, v44
    v_exp_f32 v45, v45
    v_exp_f32 v46, v46
    v_exp_f32 v47, v47
    v_exp_f32 v48, v48
    v_exp_f32 v49, v49
    v_smfmac_f32_32x32x32_bf16 v[16:31], v[180:183], v[40:47], v5
    v_exp_f32 v50, v50
    v_exp_f32 v51, v51
    v_exp_f32 v52, v52
    v_mfma_f32_32x32x16_bf16 v[32:47], v[96:99], v[8:11], 0
    v_exp_f32 v53, v53
    v_exp_f32 v54, v54
    v_exp_f32 v55, v55
    v_exp_f32 v56, v56
    v_exp_f32 v57, v57
    v_smfmac_f32_32x32x32_bf16 v[16:31], v[184:187], v[48:55], v5
    v_exp_f32 v58, v58
    v_exp_f32 v59, v59
    v_exp_f32 v60, v60
    v_exp_f32 v61, v61
    v_exp_f32 v62, v62
    v_exp_f32 v63, v63
    v_exp_f32 v32, v32
    v_exp_f32 v33, v33
    v_smfmac_f32_32x32x32_bf16 v[16:31], v[188:191], v[56:63], v5
    v_exp_f32 v34, v34
    v_exp_f32 v35, v35
    v_exp_f32 v36, v36
    v_mfma_f32_32x32x16_bf16 v[48:63], v[100:103], v[8:11], 0
    v_exp_f32 v37, v37
    v_exp_f32 v38, v38
    v_exp_f32 v39, v39
    v_exp_f32 v40, v40
    v_exp_f32 v41, v41
    v_smfmac_f32_32x32x32_bf16 v[16:31], v[192:195], v[32:39], v5
    v_exp_f32 v42, v42
    v_exp_f32 v43, v43
    v_exp_f32 v44, v44
    v_exp_f32 v45, v45
    v_exp_f32 v46, v46
    v_exp_f32 v47, v47
    v_exp_f32 v48, v48
    v_exp_f32 v49, v49
    v_smfmac_f32_32x32x32_bf16 v[16:31], v[196:199], v[40:47], v5
    v_exp_f32 v50, v50
    v_exp_f32 v51, v51
    v_exp_f32 v52, v52
    v_mfma_f32_32x32x16_bf16 v[32:47], v[104:107], v[8:11], 0
    v_exp_f32 v53, v53
    v_exp_f32 v54, v54
    v_exp_f32 v55, v55
    v_exp_f32 v56, v56
    v_exp_f32 v57, v57
    v_smfmac_f32_32x32x32_bf16 v[16:31], v[200:203], v[48:55], v5
    v_exp_f32 v58, v58
    v_exp_f32 v59, v59
    v_exp_f32 v60, v60
    v_exp_f32 v61, v61
    v_exp_f32 v62, v62
    v_exp_f32 v63, v63
    v_exp_f32 v32, v32
    v_exp_f32 v33, v33
    v_smfmac_f32_32x32x32_bf16 v[16:31], v[204:207], v[56:63], v5
    v_exp_f32 v34, v34
    v_exp_f32 v35, v35
    v_exp_f32 v36, v36
    v_mfma_f32_32x32x16_bf16 v[48:63], v[108:111], v[8:11], 0
    v_exp_f32 v37, v37
    v_exp_f32 v38, v38
    v_exp_f32 v39, v39
    v_exp_f32 v40, v40
    v_exp_f32 v41, v41
    v_smfmac_f32_32x32x32_bf16 v[16:31], v[208:211], v[32:39], v5
    v_exp_f32 v42, v42
    v_exp_f32 v43, v43
    v_exp_f32 v44, v44
    v_exp_f32 v45, v45
    v_exp_f32 v46, v46
    v_exp_f32 v47, v47
    v_exp_f32 v48, v48
    v_exp_f32 v49, v49
    v_smfmac_f32_32x32x32_bf16 v[16:31], v[212:215], v[40:47], v5
    v_exp_f32 v50, v50
    v_exp_f32 v51, v51
    v_exp_f32 v52, v52
    v_mfma_f32_32x32x16_bf16 v[32:47], v[112:115], v[8:11], 0
    v_exp_f32 v53, v53
    v_exp_f32 v54, v54
    v_exp_f32 v55, v55
    v_exp_f32 v56, v56
    v_exp_f32 v57, v57
    v_smfmac_f32_32x32x32_bf16 v[16:31], v[216:219], v[48:55], v5
    v_exp_f32 v58, v58
    v_exp_f32 v59, v59
    v_exp_f32 v60, v60
    v_exp_f32 v61, v61
    v_exp_f32 v62, v62
    v_exp_f32 v63, v63
    v_exp_f32 v32, v32
    v_exp_f32 v33, v33
    v_smfmac_f32_32x32x32_bf16 v[16:31], v[220:223], v[56:63], v5
    v_exp_f32 v34, v34
    v_exp_f32 v35, v35
    v_exp_f32 v36, v36
    v_mfma_f32_32x32x16_bf16 v[48:63], v[116:119], v[8:11], 0
    v_exp_f32 v37, v37
    v_exp_f32 v38, v38
    v_exp_f32 v39, v39
    v_exp_f32 v40, v40
    v_exp_f32 v41, v41
    v_smfmac_f32_32x32x32_bf16 v[16:31], v[224:227], v[32:39], v5
    v_exp_f32 v42, v42
    v_exp_f32 v43, v43
    v_exp_f32 v44, v44
    v_exp_f32 v45, v45
    v_exp_f32 v46, v46
    v_exp_f32 v47, v47
    v_exp_f32 v48, v48
    v_exp_f32 v49, v49
    v_smfmac_f32_32x32x32_bf16 v[16:31], v[228:231], v[40:47], v5
    v_exp_f32 v50, v50
    v_exp_f32 v51, v51
    v_exp_f32 v52, v52
    v_mfma_f32_32x32x16_bf16 v[32:47], v[120:123], v[8:11], 0
    v_exp_f32 v53, v53
    v_exp_f32 v54, v54
    v_exp_f32 v55, v55
    v_exp_f32 v56, v56
    v_exp_f32 v57, v57
    v_smfmac_f32_32x32x32_bf16 v[16:31], v[232:235], v[48:55], v5
    v_exp_f32 v58, v58
    v_exp_f32 v59, v59
    v_exp_f32 v60, v60
    v_exp_f32 v61, v61
    v_exp_f32 v62, v62
    v_exp_f32 v63, v63
    v_exp_f32 v32, v32
    v_exp_f32 v33, v33
    v_smfmac_f32_32x32x32_bf16 v[16:31], v[236:239], v[56:63], v5
    v_exp_f32 v34, v34
    v_exp_f32 v35, v35
    v_exp_f32 v36, v36
    v_mfma_f32_32x32x16_bf16 v[48:63], v[124:127], v[8:11], 0
    ds_read_b128 v[8:11], v1 offset:7168
    v_exp_f32 v37, v37
    v_exp_f32 v38, v38
    v_exp_f32 v39, v39
    v_exp_f32 v40, v40
    v_exp_f32 v41, v41
    v_smfmac_f32_32x32x32_bf16 v[16:31], v[240:243], v[32:39], v5
    v_exp_f32 v42, v42
    v_exp_f32 v43, v43
    v_exp_f32 v44, v44
    v_exp_f32 v45, v45
    v_exp_f32 v46, v46
    v_exp_f32 v47, v47
    v_exp_f32 v48, v48
    v_exp_f32 v49, v49
    v_smfmac_f32_32x32x32_bf16 v[16:31], v[244:247], v[40:47], v5
    v_exp_f32 v50, v50
    v_exp_f32 v51, v51
    v_exp_f32 v52, v52
    s_waitcnt lgkmcnt(0)
    v_mfma_f32_32x32x16_bf16 v[32:47], v[64:67], v[8:11], 0
    v_exp_f32 v53, v53
    v_exp_f32 v54, v54
    v_exp_f32 v55, v55
    v_exp_f32 v56, v56
    v_exp_f32 v57, v57
    v_smfmac_f32_32x32x32_bf16 v[16:31], v[248:251], v[48:55], v5
    v_exp_f32 v58, v58
    v_exp_f32 v59, v59
    v_exp_f32 v60, v60
    v_exp_f32 v61, v61
    v_exp_f32 v62, v62
    v_exp_f32 v63, v63
    v_exp_f32 v32, v32
    v_exp_f32 v33, v33
    v_smfmac_f32_32x32x32_bf16 v[16:31], v[252:255], v[56:63], v5
    v_exp_f32 v34, v34
    v_exp_f32 v35, v35
    v_exp_f32 v36, v36
    v_mfma_f32_32x32x16_bf16 v[48:63], v[68:71], v[8:11], 0
    v_exp_f32 v37, v37
    v_exp_f32 v38, v38
    v_exp_f32 v39, v39
    v_exp_f32 v40, v40
    v_exp_f32 v41, v41
    v_exp_f32 v42, v42
    v_exp_f32 v43, v43
    v_exp_f32 v44, v44
    ds_write_addtid_b32 v16 offset:23552
    ds_write_addtid_b32 v17 offset:23808
    ds_write_addtid_b32 v18 offset:24064
    v_exp_f32 v45, v45
    ds_write_addtid_b32 v19 offset:24320
    ds_write_addtid_b32 v20 offset:24576
    ds_write_addtid_b32 v21 offset:24832
    v_exp_f32 v46, v46
    ds_write_addtid_b32 v22 offset:25088
    ds_write_addtid_b32 v23 offset:25344
    ds_write_addtid_b32 v24 offset:25600
    v_mfma_f32_32x32x8_bf16 v[16:31], v[6:7], v[6:7], 0
    v_exp_f32 v47, v47
    v_exp_f32 v48, v48
    v_exp_f32 v49, v49
    v_exp_f32 v50, v50
    v_smfmac_f32_32x32x32_bf16 v[16:31], v[128:131], v[32:39], v5
    v_exp_f32 v51, v51
    v_exp_f32 v52, v52
    v_exp_f32 v53, v53
    v_smfmac_f32_32x32x32_bf16 v[16:31], v[132:135], v[40:47], v5
    v_exp_f32 v54, v54
    v_exp_f32 v55, v55
    v_exp_f32 v56, v56
    v_mfma_f32_32x32x16_bf16 v[32:47], v[72:75], v[8:11], 0
    ds_write_addtid_b32 v5 offset:25856
    v_exp_f32 v57, v57
    v_exp_f32 v58, v58
    v_exp_f32 v59, v59
    v_smfmac_f32_32x32x32_bf16 v[16:31], v[136:139], v[48:55], v5
    v_exp_f32 v60, v60
    v_exp_f32 v61, v61
    v_exp_f32 v62, v62
    v_exp_f32 v63, v63
    s_nop 2
    v_exp_f32 v32, v32
    v_exp_f32 v33, v33
    v_smfmac_f32_32x32x32_bf16 v[16:31], v[140:143], v[56:63], v5
    v_exp_f32 v34, v34
    v_exp_f32 v35, v35
    v_exp_f32 v36, v36
    v_mfma_f32_32x32x16_bf16 v[48:63], v[76:79], v[8:11], 0
    v_exp_f32 v37, v37
    v_exp_f32 v38, v38
    v_exp_f32 v39, v39
    v_exp_f32 v40, v40
    v_exp_f32 v41, v41
    v_smfmac_f32_32x32x32_bf16 v[16:31], v[144:147], v[32:39], v5
    v_exp_f32 v42, v42
    v_exp_f32 v43, v43
    v_exp_f32 v44, v44
    v_exp_f32 v45, v45
    v_exp_f32 v46, v46
    v_exp_f32 v47, v47
    v_exp_f32 v48, v48
    v_exp_f32 v49, v49
    v_smfmac_f32_32x32x32_bf16 v[16:31], v[148:151], v[40:47], v5
    v_exp_f32 v50, v50
    v_exp_f32 v51, v51
    v_exp_f32 v52, v52
    v_mfma_f32_32x32x16_bf16 v[32:47], v[80:83], v[8:11], 0
    v_exp_f32 v53, v53
    v_exp_f32 v54, v54
    v_exp_f32 v55, v55
    v_exp_f32 v56, v56
    v_exp_f32 v57, v57
    v_smfmac_f32_32x32x32_bf16 v[16:31], v[152:155], v[48:55], v5
    v_exp_f32 v58, v58
    v_exp_f32 v59, v59
    v_exp_f32 v60, v60
    v_exp_f32 v61, v61
    v_exp_f32 v62, v62
    v_exp_f32 v63, v63
    v_exp_f32 v32, v32
    v_exp_f32 v33, v33
    v_smfmac_f32_32x32x32_bf16 v[16:31], v[156:159], v[56:63], v5
    v_exp_f32 v34, v34
    v_exp_f32 v35, v35
    v_exp_f32 v36, v36
    v_mfma_f32_32x32x16_bf16 v[48:63], v[84:87], v[8:11], 0
    v_exp_f32 v37, v37
    v_exp_f32 v38, v38
    v_exp_f32 v39, v39
    v_exp_f32 v40, v40
    v_exp_f32 v41, v41
    v_smfmac_f32_32x32x32_bf16 v[16:31], v[160:163], v[32:39], v5
    v_exp_f32 v42, v42
    v_exp_f32 v43, v43
    v_exp_f32 v44, v44
    v_exp_f32 v45, v45
    v_exp_f32 v46, v46
    v_exp_f32 v47, v47
    v_exp_f32 v48, v48
    v_exp_f32 v49, v49
    v_smfmac_f32_32x32x32_bf16 v[16:31], v[164:167], v[40:47], v5
    v_exp_f32 v50, v50
    v_exp_f32 v51, v51
    v_exp_f32 v52, v52
    v_mfma_f32_32x32x16_bf16 v[32:47], v[88:91], v[8:11], 0
    v_exp_f32 v53, v53
    v_exp_f32 v54, v54
    v_exp_f32 v55, v55
    v_exp_f32 v56, v56
    v_exp_f32 v57, v57
    v_smfmac_f32_32x32x32_bf16 v[16:31], v[168:171], v[48:55], v5
    v_exp_f32 v58, v58
    v_exp_f32 v59, v59
    v_exp_f32 v60, v60
    v_exp_f32 v61, v61
    v_exp_f32 v62, v62
    v_exp_f32 v63, v63
    v_exp_f32 v32, v32
    v_exp_f32 v33, v33
    v_smfmac_f32_32x32x32_bf16 v[16:31], v[172:175], v[56:63], v5
    v_exp_f32 v34, v34
    v_exp_f32 v35, v35
    v_exp_f32 v36, v36
    v_mfma_f32_32x32x16_bf16 v[48:63], v[92:95], v[8:11], 0
    v_exp_f32 v37, v37
    v_exp_f32 v38, v38
    v_exp_f32 v39, v39
    v_exp_f32 v40, v40
    v_exp_f32 v41, v41
    v_smfmac_f32_32x32x32_bf16 v[16:31], v[176:179], v[32:39], v5
    v_exp_f32 v42, v42
    v_exp_f32 v43, v43
    v_exp_f32 v44, v44
    v_exp_f32 v45, v45
    v_exp_f32 v46, v46
    v_exp_f32 v47, v47
    v_exp_f32 v48, v48
    v_exp_f32 v49, v49
    v_smfmac_f32_32x32x32_bf16 v[16:31], v[180:183], v[40:47], v5
    v_exp_f32 v50, v50
    v_exp_f32 v51, v51
    v_exp_f32 v52, v52
    v_mfma_f32_32x32x16_bf16 v[32:47], v[96:99], v[8:11], 0
    v_exp_f32 v53, v53
    v_exp_f32 v54, v54
    v_exp_f32 v55, v55
    v_exp_f32 v56, v56
    v_exp_f32 v57, v57
    v_smfmac_f32_32x32x32_bf16 v[16:31], v[184:187], v[48:55], v5
    v_exp_f32 v58, v58
    v_exp_f32 v59, v59
    v_exp_f32 v60, v60
    v_exp_f32 v61, v61
    v_exp_f32 v62, v62
    v_exp_f32 v63, v63
    v_exp_f32 v32, v32
    v_exp_f32 v33, v33
    v_smfmac_f32_32x32x32_bf16 v[16:31], v[188:191], v[56:63], v5
    v_exp_f32 v34, v34
    v_exp_f32 v35, v35
    v_exp_f32 v36, v36
    v_mfma_f32_32x32x16_bf16 v[48:63], v[100:103], v[8:11], 0
    v_exp_f32 v37, v37
    v_exp_f32 v38, v38
    v_exp_f32 v39, v39
    v_exp_f32 v40, v40
    v_exp_f32 v41, v41
    v_smfmac_f32_32x32x32_bf16 v[16:31], v[192:195], v[32:39], v5
    v_exp_f32 v42, v42
    v_exp_f32 v43, v43
    v_exp_f32 v44, v44
    v_exp_f32 v45, v45
    v_exp_f32 v46, v46
    v_exp_f32 v47, v47
    v_exp_f32 v48, v48
    v_exp_f32 v49, v49
    v_smfmac_f32_32x32x32_bf16 v[16:31], v[196:199], v[40:47], v5
    v_exp_f32 v50, v50
    v_exp_f32 v51, v51
    v_exp_f32 v52, v52
    v_mfma_f32_32x32x16_bf16 v[32:47], v[104:107], v[8:11], 0
    v_exp_f32 v53, v53
    v_exp_f32 v54, v54
    v_exp_f32 v55, v55
    v_exp_f32 v56, v56
    v_exp_f32 v57, v57
    v_smfmac_f32_32x32x32_bf16 v[16:31], v[200:203], v[48:55], v5
    v_exp_f32 v58, v58
    v_exp_f32 v59, v59
    v_exp_f32 v60, v60
    v_exp_f32 v61, v61
    v_exp_f32 v62, v62
    v_exp_f32 v63, v63
    v_exp_f32 v32, v32
    v_exp_f32 v33, v33
    v_smfmac_f32_32x32x32_bf16 v[16:31], v[204:207], v[56:63], v5
    v_exp_f32 v34, v34
    v_exp_f32 v35, v35
    v_exp_f32 v36, v36
    v_mfma_f32_32x32x16_bf16 v[48:63], v[108:111], v[8:11], 0
    v_exp_f32 v37, v37
    v_exp_f32 v38, v38
    v_exp_f32 v39, v39
    v_exp_f32 v40, v40
    v_exp_f32 v41, v41
    v_smfmac_f32_32x32x32_bf16 v[16:31], v[208:211], v[32:39], v5
    v_exp_f32 v42, v42
    v_exp_f32 v43, v43
    v_exp_f32 v44, v44
    v_exp_f32 v45, v45
    v_exp_f32 v46, v46
    v_exp_f32 v47, v47
    v_exp_f32 v48, v48
    v_exp_f32 v49, v49
    v_smfmac_f32_32x32x32_bf16 v[16:31], v[212:215], v[40:47], v5
    v_exp_f32 v50, v50
    v_exp_f32 v51, v51
    v_exp_f32 v52, v52
    v_mfma_f32_32x32x16_bf16 v[32:47], v[112:115], v[8:11], 0
    v_exp_f32 v53, v53
    v_exp_f32 v54, v54
    v_exp_f32 v55, v55
    v_exp_f32 v56, v56
    v_exp_f32 v57, v57
    v_smfmac_f32_32x32x32_bf16 v[16:31], v[216:219], v[48:55], v5
    v_exp_f32 v58, v58
    v_exp_f32 v59, v59
    v_exp_f32 v60, v60
    v_exp_f32 v61, v61
    v_exp_f32 v62, v62
    v_exp_f32 v63, v63
    v_exp_f32 v32, v32
    v_exp_f32 v33, v33
    v_smfmac_f32_32x32x32_bf16 v[16:31], v[220:223], v[56:63], v5
    v_exp_f32 v34, v34
    v_exp_f32 v35, v35
    v_exp_f32 v36, v36
    v_mfma_f32_32x32x16_bf16 v[48:63], v[116:119], v[8:11], 0
    v_exp_f32 v37, v37
    v_exp_f32 v38, v38
    v_exp_f32 v39, v39
    v_exp_f32 v40, v40
    v_exp_f32 v41, v41
    v_smfmac_f32_32x32x32_bf16 v[16:31], v[224:227], v[32:39], v5
    v_exp_f32 v42, v42
    v_exp_f32 v43, v43
    v_exp_f32 v44, v44
    v_exp_f32 v45, v45
    v_exp_f32 v46, v46
    v_exp_f32 v47, v47
    v_exp_f32 v48, v48
    v_exp_f32 v49, v49
    v_smfmac_f32_32x32x32_bf16 v[16:31], v[228:231], v[40:47], v5
    v_exp_f32 v50, v50
    v_exp_f32 v51, v51
    v_exp_f32 v52, v52
    v_mfma_f32_32x32x16_bf16 v[32:47], v[120:123], v[8:11], 0
    v_exp_f32 v53, v53
    v_exp_f32 v54, v54
    v_exp_f32 v55, v55
    v_exp_f32 v56, v56
    v_exp_f32 v57, v57
    v_smfmac_f32_32x32x32_bf16 v[16:31], v[232:235], v[48:55], v5
    v_exp_f32 v58, v58
    v_exp_f32 v59, v59
    v_exp_f32 v60, v60
    v_exp_f32 v61, v61
    v_exp_f32 v62, v62
    v_exp_f32 v63, v63
    v_exp_f32 v32, v32
    v_exp_f32 v33, v33
    v_smfmac_f32_32x32x32_bf16 v[16:31], v[236:239], v[56:63], v5
    v_exp_f32 v34, v34
    v_exp_f32 v35, v35
    v_exp_f32 v36, v36
    v_mfma_f32_32x32x16_bf16 v[48:63], v[124:127], v[8:11], 0
    v_exp_f32 v37, v37
    v_exp_f32 v38, v38
    v_exp_f32 v39, v39
    v_exp_f32 v40, v40
    v_exp_f32 v41, v41
    v_smfmac_f32_32x32x32_bf16 v[16:31], v[240:243], v[32:39], v5
    v_exp_f32 v42, v42
    v_exp_f32 v43, v43
    v_exp_f32 v44, v44
    v_exp_f32 v45, v45
    v_exp_f32 v46, v46
    v_exp_f32 v47, v47
    v_exp_f32 v48, v48
    v_exp_f32 v49, v49
    v_smfmac_f32_32x32x32_bf16 v[16:31], v[244:247], v[40:47], v5
    v_exp_f32 v50, v50
    v_exp_f32 v51, v51
    v_exp_f32 v52, v52
    v_exp_f32 v53, v53
    v_exp_f32 v54, v54
    v_exp_f32 v55, v55
    v_exp_f32 v56, v56
    v_exp_f32 v57, v57
    v_smfmac_f32_32x32x32_bf16 v[16:31], v[248:251], v[48:55], v5
    v_exp_f32 v58, v58
    v_exp_f32 v59, v59
    v_exp_f32 v60, v60
    v_exp_f32 v61, v61
    v_exp_f32 v62, v62
    v_exp_f32 v63, v63
    s_nop 1
    v_smfmac_f32_32x32x32_bf16 v[16:31], v[252:255], v[56:63], v5
    s_nop 11
    ds_write_addtid_b32 v16 offset:26112
    ds_write_addtid_b32 v17 offset:26368
    ds_write_addtid_b32 v18 offset:26624
    ds_write_addtid_b32 v19 offset:26880
    ds_write_addtid_b32 v20 offset:27136
    ds_write_addtid_b32 v21 offset:27392
    ds_write_addtid_b32 v22 offset:27648
    ds_write_addtid_b32 v23 offset:27904
    ds_write_addtid_b32 v24 offset:28160
K2_ctail:
    s_waitcnt lgkmcnt(0)
    s_barrier
    s_barrier
K2_final:
    v_mov_b32 v13, 98304
    s_waitcnt lgkmcnt(0)
    s_barrier
    ds_read_b32 v14, v13 offset:48
    s_waitcnt lgkmcnt(0)
    v_readfirstlane_b32 s53, v14
    s_nop 0
    s_cmp_gt_u32 s53, s44
    s_cbranch_scc1 K2_unsafe
K2_exit:
    s_endpgm
K2_service:
    s_mov_b32 s10, 2097152
    s_mov_b32 s11, 0x20000
    s_mov_b32 s18, 2097152
    s_mov_b32 s19, 0x20000
    s_load_dwordx4 s[32:35], s[0:1], 56
    s_load_dwordx2 s[28:29], s[0:1], 72
    s_mov_b32 s30, 1835008
    s_mov_b32 s31, 0x20000
    s_mov_b32 s26, 1835008
    s_mov_b32 s27, 0x20000
    s_mul_i32 s47, s50, 14
    s_add_u32 s47, s47, s51
    s_cmp_lt_u32 s51, 28
    s_cselect_b32 s45, 1, 0
    s_andn2_b32 s45, s45, s50
    v_and_b32 v13, 31, v0
    v_mul_u32_u24 v13, 2560, v13
    v_lshlrev_b32 v12, 2, v0
    v_add_u32 v12, 98304, v12
    v_mov_b32 v14, 0
    ds_write_b32 v13, v14 offset:10496
    ds_write_b32 v12, v14
    v_and_b32 v16, 2, v0
    v_cmp_ne_u32 vcc, 0, v16
    v_mov_b32 v16, 0x4444
    v_mov_b32 v17, 0xeeee
    v_mov_b32 v5, 1
    v_cndmask_b32 v2, v16, v17, vcc
    v_lshrrev_b32 v18, 4, v0
    v_and_b32 v19, 15, v0
    v_lshlrev_b32 v16, 4, v19
    v_lshl_add_u32 v3, v18, 11, v16
    v_and_b32 v20, 3, v0
    v_mul_u32_u24 v6, 20480, v20
    v_add_u32 v6, 10496, v6
    v_lshlrev_b32 v16, 2, v20
    v_add_u32 v111, 98304, v16
    v_mov_b32 v7, 98304
    v_bfe_u32 v16, v0, 1, 1
    v_lshl_add_u32 v16, v16, 2, v18
    v_bfe_u32 v21, v0, 2, 2
    v_lshl_add_u32 v16, v16, 2, v21
    v_and_b32 v17, 1, v0
    v_lshl_add_u32 v16, v16, 1, v17
    v_lshlrev_b32 v16, 2, v16
    v_add_u32 v8, 8192, v16
    v_add_u32 v110, 49152, v16
    v_bfe_u32 v16, v0, 1, 4
    v_lshrrev_b32 v22, 5, v0
    v_lshl_add_u32 v16, v16, 1, v22
    v_lshl_add_u32 v16, v16, 1, v17
    s_lshl_b32 s52, s46, 2
    s_add_u32 s52, s52, 97280
    v_lshl_add_u32 v4, v16, 4, s52
    v_add_u32 v9, 90112, v1
    v_lshrrev_b32 v112, 1, v0
    v_mul_u32_u24 v112, 3584, v112
    v_lshl_add_u32 v112, v17, 4, v112
    v_lshrrev_b32 v113, 2, v0
    v_lshlrev_b32 v113, 10, v113
    v_lshl_add_u32 v113, v20, 4, v113
    v_lshlrev_b32 v115, 2, v0
    s_mul_i32 s58, s46, 13312
    s_add_u32 s58, s58, 99584
    s_and_b32 s52, s46, 1
    s_lshl_b32 s52, s52, 9
    s_add_u32 s52, s52, s58
    v_lshl_add_u32 v100, v18, 4, s52
    s_mov_b32 s52, s58
    v_lshlrev_b32 v20, 3, v20
    v_lshl_add_u32 v101, v18, 3, v21
    v_lshl_add_u32 v101, v101, 5, v20
    v_add_u32 v101, s52, v101
    v_lshl_add_u32 v102, v22, 3, v21
    v_lshl_add_u32 v102, v102, 6, v20
    v_and_b32 v16, 1, v18
    v_lshl_add_u32 v102, v16, 5, v102
    v_add_u32 v102, s52, v102
    s_lshl_b32 s52, s46, 6
    s_add_u32 s52, s52, 152832
    v_lshl_add_u32 v103, v18, 4, s52
    s_lshl_b32 s52, s46, 2
    v_add_u32 v104, s52, v7
    v_lshlrev_b32 v105, 2, v19
    v_add_u32 v105, 152832, v105
    s_lshl_b32 s52, s46, 5
    s_add_u32 s52, s52, 153088
    v_lshl_add_u32 v106, v19, 1, s52
    v_lshl_add_u32 v107, v22, 4, s52
    v_mov_b32 v108, 0
    v_lshlrev_b32 v12, 3, v0
    s_mov_b32 s52, 2760704
    s_lshl_b32 s53, s46, 1
    s_add_u32 s54, s53, s49
    s_lshl_b32 s53, s53, 10
    s_waitcnt lgkmcnt(0)
    buffer_load_dwordx2 v[14:15], v12, s[12:15], s52 offen
    s_add_u32 s55, s54, 0
    s_and_b32 s55, s55, 7
    s_lshl_b32 s55, s55, 10
    s_add_u32 m0, s53, 0
    s_add_u32 s55, s55, s43
    buffer_load_dwordx4 v1, s[12:15], s55 offen lds
    s_add_u32 s55, s54, 1
    s_and_b32 s55, s55, 7
    s_lshl_b32 s55, s55, 10
    s_add_u32 m0, s53, 1024
    s_add_u32 s55, s55, s43
    buffer_load_dwordx4 v1, s[12:15], s55 offen lds
    s_bitcmp1_b32 s40, 1
    s_cselect_b64 s[24:25], s[34:35], s[32:33]
    s_setprio 2
    s_waitcnt vmcnt(2)
    v_max_u32 v14, v14, v15
    s_nop 1
    v_max_u32_dpp v14, v14, v14 row_shr:1 row_mask:0xf bank_mask:0xf
    s_nop 1
    v_max_u32_dpp v14, v14, v14 row_shr:2 row_mask:0xf bank_mask:0xf
    s_nop 1
    v_max_u32_dpp v14, v14, v14 row_shr:4 row_mask:0xf bank_mask:0xf
    s_nop 1
    v_max_u32_dpp v14, v14, v14 row_shr:8 row_mask:0xf bank_mask:0xf
    s_nop 1
    v_max_u32_dpp v14, v14, v14 row_bcast:15 row_mask:0xa bank_mask:0xf
    s_nop 1
    v_max_u32_dpp v14, v14, v14 row_bcast:31 row_mask:0xc bank_mask:0xf
    s_nop 1
    v_readlane_b32 s48, v14, 63
    s_nop 3
    s_andn2_b32 s42, 2047, s48
    s_lshr_b32 s52, s42, 3
    s_cmp_eq_u32 s52, s41
    s_cselect_b32 s45, 0, s45
    s_cmp_eq_u32 s2, 248
    s_cbranch_scc0 K2_nospare
    s_lshr_b32 s53, s52, 5
    s_and_b32 s52, s52, 31
    s_mul_i32 s47, s53, 14
    s_add_u32 s47, s47, s52
    s_cmp_lt_u32 s52, 28
    s_cselect_b32 s45, 1, 0
    s_andn2_b32 s45, s45, s53
K2_nospare:
    s_waitcnt vmcnt(0)
    s_barrier
    s_cmp_eq_u32 s45, 0
    s_cbranch_scc1 K2_project
    s_lshl_b32 s54, s46, 14
    s_add_u32 s54, s54, 2228224
    s_add_u32 s52, s49, 0
    s_and_b32 s52, s52, 7
    s_lshl_b32 s52, s52, 16
    s_add_u32 s52, s52, s54
    s_waitcnt vmcnt(12)
    buffer_load_dwordx4 v[128:131], v1, s[12:15], s52 offen offset:0
    buffer_load_dwordx4 v[132:135], v1, s[12:15], s52 offen offset:1024
    buffer_load_dwordx4 v[136:139], v1, s[12:15], s52 offen offset:2048
    buffer_load_dwordx4 v[140:143], v1, s[12:15], s52 offen offset:3072
    s_add_u32 s52, s52, 4096
    s_waitcnt vmcnt(12)
    buffer_load_dwordx4 v[144:147], v1, s[12:15], s52 offen offset:0
    buffer_load_dwordx4 v[148:151], v1, s[12:15], s52 offen offset:1024
    buffer_load_dwordx4 v[152:155], v1, s[12:15], s52 offen offset:2048
    buffer_load_dwordx4 v[156:159], v1, s[12:15], s52 offen offset:3072
    s_add_u32 s52, s52, 4096
    s_waitcnt vmcnt(12)
    buffer_load_dwordx4 v[160:163], v1, s[12:15], s52 offen offset:0
    buffer_load_dwordx4 v[164:167], v1, s[12:15], s52 offen offset:1024
    buffer_load_dwordx4 v[168:171], v1, s[12:15], s52 offen offset:2048
    buffer_load_dwordx4 v[172:175], v1, s[12:15], s52 offen offset:3072
    s_add_u32 s52, s52, 4096
    s_waitcnt vmcnt(12)
    buffer_load_dwordx4 v[176:179], v1, s[12:15], s52 offen offset:0
    buffer_load_dwordx4 v[180:183], v1, s[12:15], s52 offen offset:1024
    buffer_load_dwordx4 v[184:187], v1, s[12:15], s52 offen offset:2048
    buffer_load_dwordx4 v[188:191], v1, s[12:15], s52 offen offset:3072
    s_add_u32 s52, s49, 1
    s_and_b32 s52, s52, 7
    s_lshl_b32 s52, s52, 16
    s_add_u32 s52, s52, s54
    s_waitcnt vmcnt(12)
    buffer_load_dwordx4 v[192:195], v1, s[12:15], s52 offen offset:0
    buffer_load_dwordx4 v[196:199], v1, s[12:15], s52 offen offset:1024
    buffer_load_dwordx4 v[200:203], v1, s[12:15], s52 offen offset:2048
    buffer_load_dwordx4 v[204:207], v1, s[12:15], s52 offen offset:3072
    s_add_u32 s52, s52, 4096
    s_waitcnt vmcnt(12)
    buffer_load_dwordx4 v[208:211], v1, s[12:15], s52 offen offset:0
    buffer_load_dwordx4 v[212:215], v1, s[12:15], s52 offen offset:1024
    buffer_load_dwordx4 v[216:219], v1, s[12:15], s52 offen offset:2048
    buffer_load_dwordx4 v[220:223], v1, s[12:15], s52 offen offset:3072
    s_add_u32 s52, s52, 4096
    s_waitcnt vmcnt(12)
    buffer_load_dwordx4 v[224:227], v1, s[12:15], s52 offen offset:0
    buffer_load_dwordx4 v[228:231], v1, s[12:15], s52 offen offset:1024
    buffer_load_dwordx4 v[232:235], v1, s[12:15], s52 offen offset:2048
    buffer_load_dwordx4 v[236:239], v1, s[12:15], s52 offen offset:3072
    s_add_u32 s52, s52, 4096
    s_waitcnt vmcnt(12)
    buffer_load_dwordx4 v[240:243], v1, s[12:15], s52 offen offset:0
    buffer_load_dwordx4 v[244:247], v1, s[12:15], s52 offen offset:1024
    buffer_load_dwordx4 v[248:251], v1, s[12:15], s52 offen offset:2048
    buffer_load_dwordx4 v[252:255], v1, s[12:15], s52 offen offset:3072
    s_waitcnt vmcnt(4)
    s_and_b32 s55, s46, 1
    s_mul_i32 s53, s55, 917504
    s_lshl_b32 s52, s47, 5
    s_add_u32 s53, s53, s52
    s_lshl_b32 s56, s47, 1
    s_lshl_b32 s57, s42, 10
    s_add_u32 m0, s58, 12288
    s_nop 0
    buffer_load_dwordx4 v1, s[8:11], s57 offen lds
    s_add_u32 s57, s56, 0
    s_and_b32 s57, s57, 7
    s_lshl_b32 s59, s57, 10
    s_add_u32 m0, s59, s58
    s_mul_i32 s57, s57, 114688
    s_add_u32 s57, s57, s53
    buffer_load_dwordx4 v112, s[24:27], s57 offen lds
    s_add_u32 s57, s56, 1
    s_and_b32 s57, s57, 7
    s_lshl_b32 s59, s57, 10
    s_add_u32 m0, s59, s58
    s_mul_i32 s57, s57, 114688
    s_add_u32 s57, s57, s53
    buffer_load_dwordx4 v112, s[24:27], s57 offen lds
    s_add_u32 s57, s56, 2
    s_and_b32 s57, s57, 7
    s_lshl_b32 s59, s57, 10
    s_add_u32 m0, s59, s58
    s_mul_i32 s57, s57, 114688
    s_add_u32 s57, s57, s53
    buffer_load_dwordx4 v112, s[24:27], s57 offen lds
    s_add_u32 s57, s56, 3
    s_and_b32 s57, s57, 7
    s_lshl_b32 s59, s57, 10
    s_add_u32 m0, s59, s58
    s_mul_i32 s57, s57, 114688
    s_add_u32 s57, s57, s53
    s_waitcnt vmcnt(2)
    buffer_load_dwordx4 v112, s[24:27], s57 offen lds
    s_add_u32 s57, s56, 4
    s_and_b32 s57, s57, 7
    s_lshl_b32 s59, s57, 10
    s_add_u32 m0, s59, s58
    s_mul_i32 s57, s57, 114688
    s_add_u32 s57, s57, s53
    s_waitcnt vmcnt(2)
    buffer_load_dwordx4 v112, s[24:27], s57 offen lds
    s_add_u32 s57, s56, 5
    s_and_b32 s57, s57, 7
    s_lshl_b32 s59, s57, 10
    s_add_u32 m0, s59, s58
    s_mul_i32 s57, s57, 114688
    s_add_u32 s57, s57, s53
    s_waitcnt vmcnt(2)
    buffer_load_dwordx4 v112, s[24:27], s57 offen lds
    s_add_u32 s57, s56, 6
    s_and_b32 s57, s57, 7
    s_lshl_b32 s59, s57, 10
    s_add_u32 m0, s59, s58
    s_mul_i32 s57, s57, 114688
    s_add_u32 s57, s57, s53
    s_waitcnt vmcnt(2)
    buffer_load_dwordx4 v112, s[24:27], s57 offen lds
    s_add_u32 s57, s56, 7
    s_and_b32 s57, s57, 7
    s_lshl_b32 s59, s57, 10
    s_add_u32 m0, s59, s58
    s_mul_i32 s57, s57, 114688
    s_add_u32 s57, s57, s53
    s_waitcnt vmcnt(2)
    buffer_load_dwordx4 v112, s[24:27], s57 offen lds
    s_lshl_b32 s53, s47, 14
    s_lshl_b32 s52, s46, 8
    s_add_u32 s53, s53, s52
    s_waitcnt vmcnt(2)
    s_add_u32 m0, s58, 8192
    s_nop 0
    buffer_load_dwordx4 v113, s[28:31], s53 offen lds
    s_add_u32 m0, s58, 9216
    s_add_u32 s53, s53, 64
    buffer_load_dwordx4 v113, s[28:31], s53 offen lds
    s_add_u32 m0, s58, 10240
    s_add_u32 s53, s53, 64
    buffer_load_dwordx4 v113, s[28:31], s53 offen lds
    s_add_u32 m0, s58, 11264
    s_add_u32 s53, s53, 64
    buffer_load_dwordx4 v113, s[28:31], s53 offen lds
    s_waitcnt vmcnt(4)
    ds_read_b64_tr_b16 v[16:17], v101 offset:0
    ds_read_b64_tr_b16 v[18:19], v101 offset:128
    ds_read_b128 v[48:51], v100 offset:12288
    ds_read_b64_tr_b16 v[20:21], v101 offset:1024
    ds_read_b64_tr_b16 v[22:23], v101 offset:1152
    ds_read_b128 v[52:55], v100 offset:12352
    ds_read_b64_tr_b16 v[24:25], v101 offset:2048
    ds_read_b64_tr_b16 v[26:27], v101 offset:2176
    ds_read_b128 v[56:59], v100 offset:12416
    ds_read_b64_tr_b16 v[28:29], v101 offset:3072
    ds_read_b64_tr_b16 v[30:31], v101 offset:3200
    ds_read_b128 v[60:63], v100 offset:12480
    s_waitcnt lgkmcnt(0)
    ds_read_b64_tr_b16 v[32:33], v101 offset:4096
    ds_read_b64_tr_b16 v[34:35], v101 offset:4224
    ds_read_b128 v[64:67], v100 offset:12544
    ds_read_b64_tr_b16 v[36:37], v101 offset:5120
    ds_read_b64_tr_b16 v[38:39], v101 offset:5248
    ds_read_b128 v[68:71], v100 offset:12608
    ds_read_b64_tr_b16 v[40:41], v101 offset:6144
    ds_read_b64_tr_b16 v[42:43], v101 offset:6272
    ds_read_b128 v[72:75], v100 offset:12672
    ds_read_b64_tr_b16 v[44:45], v101 offset:7168
    ds_read_b64_tr_b16 v[46:47], v101 offset:7296
    ds_read_b128 v[76:79], v100 offset:12736
    s_waitcnt lgkmcnt(0)
    s_setprio 0
    v_mfma_f32_16x16x32_bf16 v[96:99], v[16:19], v[48:51], 0
    v_mfma_f32_16x16x32_bf16 v[96:99], v[20:23], v[52:55], v[96:99]
    v_mfma_f32_16x16x32_bf16 v[96:99], v[24:27], v[56:59], v[96:99]
    v_mfma_f32_16x16x32_bf16 v[96:99], v[28:31], v[60:63], v[96:99]
    v_mfma_f32_16x16x32_bf16 v[96:99], v[32:35], v[64:67], v[96:99]
    v_mfma_f32_16x16x32_bf16 v[96:99], v[36:39], v[68:71], v[96:99]
    v_mfma_f32_16x16x32_bf16 v[96:99], v[40:43], v[72:75], v[96:99]
    v_mfma_f32_16x16x32_bf16 v[96:99], v[44:47], v[76:79], v[96:99]
    s_setprio 2
    s_waitcnt vmcnt(0)
    ds_read_b64_tr_b16 v[80:81], v102 offset:8192
    ds_read_b64_tr_b16 v[82:83], v102 offset:8448
    ds_read_b64_tr_b16 v[84:85], v102 offset:9216
    ds_read_b64_tr_b16 v[86:87], v102 offset:9472
    ds_read_b64_tr_b16 v[88:89], v102 offset:10240
    ds_read_b64_tr_b16 v[90:91], v102 offset:10496
    ds_read_b64_tr_b16 v[92:93], v102 offset:11264
    ds_read_b64_tr_b16 v[94:95], v102 offset:11520
    ds_write_b128 v103, v[96:99]
    ds_write_b32 v104, v5 offset:32
    s_mov_b32 s60, 0
K2_spin_L:
    ds_read_b32 v109, v111 offset:32
    s_waitcnt lgkmcnt(0)
    v_cmp_eq_u32 vcc, 0, v109
    s_cbranch_vccz K2_spun_L
    s_sleep 1
    s_add_u32 s60, s60, 1
    s_cmp_lt_u32 s60, 0x400000
    s_cbranch_scc1 K2_spin_L
K2_spun_L:
    ds_read2_b32 v[96:97], v105 offset0:0 offset1:32
    ds_read2_b32 v[98:99], v105 offset0:16 offset1:48
    s_waitcnt lgkmcnt(0)
    v_pk_add_f32 v[96:97], v[96:97], v[98:99]
    v_cvt_pk_bf16_f32 v96, v96, v97
    v_lshlrev_b32 v97, 16, v96
    v_mul_f32 v98, 0xbfb8aa3b, v97
    v_exp_f32 v98, v98
    v_and_b32 v96, 0xffff0000, v96
    v_add_f32 v98, 1.0, v98
    v_rcp_f32 v98, v98
    s_nop 0
    v_mul_f32 v97, v97, v98
    v_cvt_pk_bf16_f32 v97, v97, v97
    v_and_b32 v97, 0xffff0000, v97
    v_mul_f32 v96, v96, v97
    v_cvt_pk_bf16_f32 v96, v96, v96
    ds_write_b16 v106, v96
    ds_read_b128 v[96:99], v107
    s_lshl_b32 s53, s46, 9
    s_add_u32 s53, s53, 2768896
    s_and_b32 s52, s47, 7
    s_lshl_b32 s52, s52, 11
    s_add_u32 s53, s53, s52
    s_waitcnt lgkmcnt(0)
    s_setprio 0
    v_mfma_f32_32x32x16_bf16 v[16:31], v[96:99], v[80:83], 0
    v_mfma_f32_32x32x16_bf16 v[32:47], v[96:99], v[84:87], 0
    v_mfma_f32_32x32x16_bf16 v[48:63], v[96:99], v[88:91], 0
    v_mfma_f32_32x32x16_bf16 v[64:79], v[96:99], v[92:95], 0
    s_setprio 2
    s_nop 15
    v_permlane32_swap_b32 v16, v32
    v_permlane32_swap_b32 v48, v64
    buffer_atomic_add_f32 v16, v115, s[12:15], s53 offen
    buffer_atomic_add_f32 v48, v115, s[12:15], s53 offen offset:256
    s_lshl_b32 s52, s47, 2
    s_add_u32 s52, s52, s46
    s_lshl_b32 s52, s52, 7
    s_add_u32 s52, s52, 2785280
    s_waitcnt vmcnt(0)
    s_mov_b64 exec, 1
    buffer_store_dword v5, v108, s[12:15], s52 offen sc1
    s_mov_b64 exec, -1
    s_branch K2_loaded
K2_project:
    s_lshl_b32 s54, s46, 14
    s_add_u32 s54, s54, 2228224
    s_add_u32 s52, s49, 0
    s_and_b32 s52, s52, 7
    s_lshl_b32 s52, s52, 16
    s_add_u32 s52, s52, s54
    s_waitcnt vmcnt(12)
    buffer_load_dwordx4 v[128:131], v1, s[12:15], s52 offen offset:0
    buffer_load_dwordx4 v[132:135], v1, s[12:15], s52 offen offset:1024
    buffer_load_dwordx4 v[136:139], v1, s[12:15], s52 offen offset:2048
    buffer_load_dwordx4 v[140:143], v1, s[12:15], s52 offen offset:3072
    s_add_u32 s52, s52, 4096
    s_waitcnt vmcnt(12)
    buffer_load_dwordx4 v[144:147], v1, s[12:15], s52 offen offset:0
    buffer_load_dwordx4 v[148:151], v1, s[12:15], s52 offen offset:1024
    buffer_load_dwordx4 v[152:155], v1, s[12:15], s52 offen offset:2048
    buffer_load_dwordx4 v[156:159], v1, s[12:15], s52 offen offset:3072
    s_add_u32 s52, s52, 4096
    s_waitcnt vmcnt(12)
    buffer_load_dwordx4 v[160:163], v1, s[12:15], s52 offen offset:0
    buffer_load_dwordx4 v[164:167], v1, s[12:15], s52 offen offset:1024
    buffer_load_dwordx4 v[168:171], v1, s[12:15], s52 offen offset:2048
    buffer_load_dwordx4 v[172:175], v1, s[12:15], s52 offen offset:3072
    s_add_u32 s52, s52, 4096
    s_waitcnt vmcnt(12)
    buffer_load_dwordx4 v[176:179], v1, s[12:15], s52 offen offset:0
    buffer_load_dwordx4 v[180:183], v1, s[12:15], s52 offen offset:1024
    buffer_load_dwordx4 v[184:187], v1, s[12:15], s52 offen offset:2048
    buffer_load_dwordx4 v[188:191], v1, s[12:15], s52 offen offset:3072
    s_add_u32 s52, s49, 1
    s_and_b32 s52, s52, 7
    s_lshl_b32 s52, s52, 16
    s_add_u32 s52, s52, s54
    s_waitcnt vmcnt(12)
    buffer_load_dwordx4 v[192:195], v1, s[12:15], s52 offen offset:0
    buffer_load_dwordx4 v[196:199], v1, s[12:15], s52 offen offset:1024
    buffer_load_dwordx4 v[200:203], v1, s[12:15], s52 offen offset:2048
    buffer_load_dwordx4 v[204:207], v1, s[12:15], s52 offen offset:3072
    s_add_u32 s52, s52, 4096
    s_waitcnt vmcnt(12)
    buffer_load_dwordx4 v[208:211], v1, s[12:15], s52 offen offset:0
    buffer_load_dwordx4 v[212:215], v1, s[12:15], s52 offen offset:1024
    buffer_load_dwordx4 v[216:219], v1, s[12:15], s52 offen offset:2048
    buffer_load_dwordx4 v[220:223], v1, s[12:15], s52 offen offset:3072
    s_add_u32 s52, s52, 4096
    s_waitcnt vmcnt(12)
    buffer_load_dwordx4 v[224:227], v1, s[12:15], s52 offen offset:0
    buffer_load_dwordx4 v[228:231], v1, s[12:15], s52 offen offset:1024
    buffer_load_dwordx4 v[232:235], v1, s[12:15], s52 offen offset:2048
    buffer_load_dwordx4 v[236:239], v1, s[12:15], s52 offen offset:3072
    s_add_u32 s52, s52, 4096
    s_waitcnt vmcnt(12)
    buffer_load_dwordx4 v[240:243], v1, s[12:15], s52 offen offset:0
    buffer_load_dwordx4 v[244:247], v1, s[12:15], s52 offen offset:1024
    buffer_load_dwordx4 v[248:251], v1, s[12:15], s52 offen offset:2048
    buffer_load_dwordx4 v[252:255], v1, s[12:15], s52 offen offset:3072
K2_loaded:
    v_mov_b64 v[12:13], 0
    s_nop 1
    v_mfma_f32_32x32x8_bf16 v[16:31], v[12:13], v[12:13], 0
    s_nop 15
    v_mfma_f32_32x32x8_bf16 v[32:47], v[12:13], v[12:13], 0
    s_nop 15
    s_mov_b64 s[62:63], 0
    s_cmp_eq_u32 s46, 0
    s_cbranch_scc0 K2_nod0
    s_mov_b32 s60, 0
K2_spin_P0:
    ds_read_b32 v64, v6 offset:0
    s_waitcnt lgkmcnt(0)
    v_cmp_eq_u32 vcc, 0, v64
    s_cbranch_vccz K2_spun_P0
    s_sleep 4
    s_add_u32 s60, s60, 1
    s_cmp_lt_u32 s60, 0x400000
    s_cbranch_scc1 K2_spin_P0
K2_spun_P0:
    ds_read2st64_b32 v[96:97], v8 offset0:8 offset1:88
    ds_read2st64_b32 v[98:99], v110 offset0:8 offset1:88
    ds_read2st64_b32 v[64:65], v8 offset0:0 offset1:1
    ds_read2st64_b32 v[66:67], v8 offset0:2 offset1:3
    ds_read2st64_b32 v[68:69], v8 offset0:4 offset1:5
    ds_read2st64_b32 v[70:71], v8 offset0:6 offset1:7
    ds_read2st64_b32 v[72:73], v8 offset0:80 offset1:81
    ds_read2st64_b32 v[74:75], v8 offset0:82 offset1:83
    ds_read2st64_b32 v[76:77], v8 offset0:84 offset1:85
    ds_read2st64_b32 v[78:79], v8 offset0:86 offset1:87
    ds_read2st64_b32 v[80:81], v110 offset0:0 offset1:1
    ds_read2st64_b32 v[82:83], v110 offset0:2 offset1:3
    ds_read2st64_b32 v[84:85], v110 offset0:4 offset1:5
    ds_read2st64_b32 v[86:87], v110 offset0:6 offset1:7
    s_waitcnt lgkmcnt(8)
    ds_read2st64_b32 v[88:89], v110 offset0:80 offset1:81
    ds_read2st64_b32 v[90:91], v110 offset0:82 offset1:83
    ds_read2st64_b32 v[92:93], v110 offset0:84 offset1:85
    ds_read2st64_b32 v[94:95], v110 offset0:86 offset1:87
    s_waitcnt lgkmcnt(0)
    v_pk_add_f32 v[96:97], v[96:97], v[98:99]
    v_pk_add_f32 v[64:65], v[64:65], v[72:73]
    v_pk_add_f32 v[66:67], v[66:67], v[74:75]
    v_pk_add_f32 v[68:69], v[68:69], v[76:77]
    v_pk_add_f32 v[70:71], v[70:71], v[78:79]
    v_add_f32 v96, v96, v97
    v_pk_add_f32 v[80:81], v[80:81], v[88:89]
    v_pk_add_f32 v[82:83], v[82:83], v[90:91]
    v_pk_add_f32 v[84:85], v[84:85], v[92:93]
    v_pk_add_f32 v[86:87], v[86:87], v[94:95]
    v_rcp_f32 v98, v96
    v_subrev_u32 v96, 0x2f800000, v96
    v_cmp_lt_u32 vcc, 0x4c000000, v96
    v_pk_add_f32 v[64:65], v[64:65], v[80:81]
    v_pk_add_f32 v[66:67], v[66:67], v[82:83]
    v_pk_add_f32 v[68:69], v[68:69], v[84:85]
    v_pk_add_f32 v[70:71], v[70:71], v[86:87]
    s_or_b64 s[62:63], s[62:63], vcc
    v_pk_mul_f32 v[64:65], v[64:65], v[98:99] op_sel_hi:[1,0]
    v_pk_mul_f32 v[66:67], v[66:67], v[98:99] op_sel_hi:[1,0]
    v_pk_mul_f32 v[68:69], v[68:69], v[98:99] op_sel_hi:[1,0]
    v_pk_mul_f32 v[70:71], v[70:71], v[98:99] op_sel_hi:[1,0]
    v_cvt_pk_bf16_f32 v104, v64, v65
    v_cvt_pk_bf16_f32 v105, v66, v67
    v_cvt_pk_bf16_f32 v106, v68, v69
    v_cvt_pk_bf16_f32 v107, v70, v71
    ds_write_b128 v9, v[104:107] offset:0
    ds_write_b32 v7, v5 offset:0
K2_nod0:
    s_mov_b32 s60, 0
K2_spin_A0:
    ds_read_b32 v64, v7 offset:0
    s_waitcnt lgkmcnt(0)
    v_cmp_eq_u32 vcc, 0, v64
    s_cbranch_vccz K2_spun_A0
    s_sleep 4
    s_add_u32 s60, s60, 1
    s_cmp_lt_u32 s60, 0x400000
    s_cbranch_scc1 K2_spin_A0
K2_spun_A0:
    ds_read_b128 v[104:107], v9 offset:0
    s_waitcnt vmcnt(16) lgkmcnt(0)
    s_setprio 0
    v_smfmac_f32_16x16x64_bf16 v[16:19], v[104:107], v[128:135], v2
    v_smfmac_f32_16x16x64_bf16 v[20:23], v[104:107], v[136:143], v2
    v_smfmac_f32_16x16x64_bf16 v[24:27], v[104:107], v[144:151], v2
    v_smfmac_f32_16x16x64_bf16 v[28:31], v[104:107], v[152:159], v2
    v_smfmac_f32_16x16x64_bf16 v[32:35], v[104:107], v[160:167], v2
    v_smfmac_f32_16x16x64_bf16 v[36:39], v[104:107], v[168:175], v2
    v_smfmac_f32_16x16x64_bf16 v[40:43], v[104:107], v[176:183], v2
    v_smfmac_f32_16x16x64_bf16 v[44:47], v[104:107], v[184:191], v2
    s_setprio 2
    s_cmp_eq_u32 s46, 1
    s_cbranch_scc0 K2_nod1
    s_mov_b32 s60, 0
K2_spin_P1:
    ds_read_b32 v64, v6 offset:2560
    s_waitcnt lgkmcnt(0)
    v_cmp_eq_u32 vcc, 0, v64
    s_cbranch_vccz K2_spun_P1
    s_sleep 4
    s_add_u32 s60, s60, 1
    s_cmp_lt_u32 s60, 0x400000
    s_cbranch_scc1 K2_spin_P1
K2_spun_P1:
    ds_read2st64_b32 v[96:97], v8 offset0:18 offset1:98
    ds_read2st64_b32 v[98:99], v110 offset0:18 offset1:98
    ds_read2st64_b32 v[64:65], v8 offset0:10 offset1:11
    ds_read2st64_b32 v[66:67], v8 offset0:12 offset1:13
    ds_read2st64_b32 v[68:69], v8 offset0:14 offset1:15
    ds_read2st64_b32 v[70:71], v8 offset0:16 offset1:17
    ds_read2st64_b32 v[72:73], v8 offset0:90 offset1:91
    ds_read2st64_b32 v[74:75], v8 offset0:92 offset1:93
    ds_read2st64_b32 v[76:77], v8 offset0:94 offset1:95
    ds_read2st64_b32 v[78:79], v8 offset0:96 offset1:97
    ds_read2st64_b32 v[80:81], v110 offset0:10 offset1:11
    ds_read2st64_b32 v[82:83], v110 offset0:12 offset1:13
    ds_read2st64_b32 v[84:85], v110 offset0:14 offset1:15
    ds_read2st64_b32 v[86:87], v110 offset0:16 offset1:17
    s_waitcnt lgkmcnt(8)
    ds_read2st64_b32 v[88:89], v110 offset0:90 offset1:91
    ds_read2st64_b32 v[90:91], v110 offset0:92 offset1:93
    ds_read2st64_b32 v[92:93], v110 offset0:94 offset1:95
    ds_read2st64_b32 v[94:95], v110 offset0:96 offset1:97
    s_waitcnt lgkmcnt(0)
    v_pk_add_f32 v[96:97], v[96:97], v[98:99]
    v_pk_add_f32 v[64:65], v[64:65], v[72:73]
    v_pk_add_f32 v[66:67], v[66:67], v[74:75]
    v_pk_add_f32 v[68:69], v[68:69], v[76:77]
    v_pk_add_f32 v[70:71], v[70:71], v[78:79]
    v_add_f32 v96, v96, v97
    v_pk_add_f32 v[80:81], v[80:81], v[88:89]
    v_pk_add_f32 v[82:83], v[82:83], v[90:91]
    v_pk_add_f32 v[84:85], v[84:85], v[92:93]
    v_pk_add_f32 v[86:87], v[86:87], v[94:95]
    v_rcp_f32 v98, v96
    v_subrev_u32 v96, 0x2f800000, v96
    v_cmp_lt_u32 vcc, 0x4c000000, v96
    v_pk_add_f32 v[64:65], v[64:65], v[80:81]
    v_pk_add_f32 v[66:67], v[66:67], v[82:83]
    v_pk_add_f32 v[68:69], v[68:69], v[84:85]
    v_pk_add_f32 v[70:71], v[70:71], v[86:87]
    s_or_b64 s[62:63], s[62:63], vcc
    v_pk_mul_f32 v[64:65], v[64:65], v[98:99] op_sel_hi:[1,0]
    v_pk_mul_f32 v[66:67], v[66:67], v[98:99] op_sel_hi:[1,0]
    v_pk_mul_f32 v[68:69], v[68:69], v[98:99] op_sel_hi:[1,0]
    v_pk_mul_f32 v[70:71], v[70:71], v[98:99] op_sel_hi:[1,0]
    v_cvt_pk_bf16_f32 v104, v64, v65
    v_cvt_pk_bf16_f32 v105, v66, v67
    v_cvt_pk_bf16_f32 v106, v68, v69
    v_cvt_pk_bf16_f32 v107, v70, v71
    ds_write_b128 v9, v[104:107] offset:1024
    ds_write_b32 v7, v5 offset:4
K2_nod1:
    s_add_u32 s52, s49, 2
    s_and_b32 s52, s52, 7
    s_lshl_b32 s52, s52, 16
    s_add_u32 s52, s52, s54
    s_waitcnt vmcnt(12)
    buffer_load_dwordx4 v[128:131], v1, s[12:15], s52 offen offset:0
    buffer_load_dwordx4 v[132:135], v1, s[12:15], s52 offen offset:1024
    buffer_load_dwordx4 v[136:139], v1, s[12:15], s52 offen offset:2048
    buffer_load_dwordx4 v[140:143], v1, s[12:15], s52 offen offset:3072
    s_add_u32 s52, s52, 4096
    s_waitcnt vmcnt(12)
    buffer_load_dwordx4 v[144:147], v1, s[12:15], s52 offen offset:0
    buffer_load_dwordx4 v[148:151], v1, s[12:15], s52 offen offset:1024
    buffer_load_dwordx4 v[152:155], v1, s[12:15], s52 offen offset:2048
    buffer_load_dwordx4 v[156:159], v1, s[12:15], s52 offen offset:3072
    s_add_u32 s52, s52, 4096
    s_waitcnt vmcnt(12)
    buffer_load_dwordx4 v[160:163], v1, s[12:15], s52 offen offset:0
    buffer_load_dwordx4 v[164:167], v1, s[12:15], s52 offen offset:1024
    buffer_load_dwordx4 v[168:171], v1, s[12:15], s52 offen offset:2048
    buffer_load_dwordx4 v[172:175], v1, s[12:15], s52 offen offset:3072
    s_add_u32 s52, s52, 4096
    s_waitcnt vmcnt(12)
    buffer_load_dwordx4 v[176:179], v1, s[12:15], s52 offen offset:0
    buffer_load_dwordx4 v[180:183], v1, s[12:15], s52 offen offset:1024
    buffer_load_dwordx4 v[184:187], v1, s[12:15], s52 offen offset:2048
    buffer_load_dwordx4 v[188:191], v1, s[12:15], s52 offen offset:3072
    s_mov_b32 s60, 0
K2_spin_A1:
    ds_read_b32 v64, v7 offset:4
    s_waitcnt lgkmcnt(0)
    v_cmp_eq_u32 vcc, 0, v64
    s_cbranch_vccz K2_spun_A1
    s_sleep 4
    s_add_u32 s60, s60, 1
    s_cmp_lt_u32 s60, 0x400000
    s_cbranch_scc1 K2_spin_A1
K2_spun_A1:
    ds_read_b128 v[104:107], v9 offset:1024
    s_waitcnt vmcnt(16) lgkmcnt(0)
    s_setprio 0
    v_smfmac_f32_16x16x64_bf16 v[16:19], v[104:107], v[192:199], v2
    v_smfmac_f32_16x16x64_bf16 v[20:23], v[104:107], v[200:207], v2
    v_smfmac_f32_16x16x64_bf16 v[24:27], v[104:107], v[208:215], v2
    v_smfmac_f32_16x16x64_bf16 v[28:31], v[104:107], v[216:223], v2
    v_smfmac_f32_16x16x64_bf16 v[32:35], v[104:107], v[224:231], v2
    v_smfmac_f32_16x16x64_bf16 v[36:39], v[104:107], v[232:239], v2
    v_smfmac_f32_16x16x64_bf16 v[40:43], v[104:107], v[240:247], v2
    v_smfmac_f32_16x16x64_bf16 v[44:47], v[104:107], v[248:255], v2
    s_setprio 2
    s_cmp_eq_u32 s46, 2
    s_cbranch_scc0 K2_nod2
    s_mov_b32 s60, 0
K2_spin_P2:
    ds_read_b32 v64, v6 offset:5120
    s_waitcnt lgkmcnt(0)
    v_cmp_eq_u32 vcc, 0, v64
    s_cbranch_vccz K2_spun_P2
    s_sleep 4
    s_add_u32 s60, s60, 1
    s_cmp_lt_u32 s60, 0x400000
    s_cbranch_scc1 K2_spin_P2
K2_spun_P2:
    ds_read2st64_b32 v[96:97], v8 offset0:28 offset1:108
    ds_read2st64_b32 v[98:99], v110 offset0:28 offset1:108
    ds_read2st64_b32 v[64:65], v8 offset0:20 offset1:21
    ds_read2st64_b32 v[66:67], v8 offset0:22 offset1:23
    ds_read2st64_b32 v[68:69], v8 offset0:24 offset1:25
    ds_read2st64_b32 v[70:71], v8 offset0:26 offset1:27
    ds_read2st64_b32 v[72:73], v8 offset0:100 offset1:101
    ds_read2st64_b32 v[74:75], v8 offset0:102 offset1:103
    ds_read2st64_b32 v[76:77], v8 offset0:104 offset1:105
    ds_read2st64_b32 v[78:79], v8 offset0:106 offset1:107
    ds_read2st64_b32 v[80:81], v110 offset0:20 offset1:21
    ds_read2st64_b32 v[82:83], v110 offset0:22 offset1:23
    ds_read2st64_b32 v[84:85], v110 offset0:24 offset1:25
    ds_read2st64_b32 v[86:87], v110 offset0:26 offset1:27
    s_waitcnt lgkmcnt(8)
    ds_read2st64_b32 v[88:89], v110 offset0:100 offset1:101
    ds_read2st64_b32 v[90:91], v110 offset0:102 offset1:103
    ds_read2st64_b32 v[92:93], v110 offset0:104 offset1:105
    ds_read2st64_b32 v[94:95], v110 offset0:106 offset1:107
    s_waitcnt lgkmcnt(0)
    v_pk_add_f32 v[96:97], v[96:97], v[98:99]
    v_pk_add_f32 v[64:65], v[64:65], v[72:73]
    v_pk_add_f32 v[66:67], v[66:67], v[74:75]
    v_pk_add_f32 v[68:69], v[68:69], v[76:77]
    v_pk_add_f32 v[70:71], v[70:71], v[78:79]
    v_add_f32 v96, v96, v97
    v_pk_add_f32 v[80:81], v[80:81], v[88:89]
    v_pk_add_f32 v[82:83], v[82:83], v[90:91]
    v_pk_add_f32 v[84:85], v[84:85], v[92:93]
    v_pk_add_f32 v[86:87], v[86:87], v[94:95]
    v_rcp_f32 v98, v96
    v_subrev_u32 v96, 0x2f800000, v96
    v_cmp_lt_u32 vcc, 0x4c000000, v96
    v_pk_add_f32 v[64:65], v[64:65], v[80:81]
    v_pk_add_f32 v[66:67], v[66:67], v[82:83]
    v_pk_add_f32 v[68:69], v[68:69], v[84:85]
    v_pk_add_f32 v[70:71], v[70:71], v[86:87]
    s_or_b64 s[62:63], s[62:63], vcc
    v_pk_mul_f32 v[64:65], v[64:65], v[98:99] op_sel_hi:[1,0]
    v_pk_mul_f32 v[66:67], v[66:67], v[98:99] op_sel_hi:[1,0]
    v_pk_mul_f32 v[68:69], v[68:69], v[98:99] op_sel_hi:[1,0]
    v_pk_mul_f32 v[70:71], v[70:71], v[98:99] op_sel_hi:[1,0]
    v_cvt_pk_bf16_f32 v104, v64, v65
    v_cvt_pk_bf16_f32 v105, v66, v67
    v_cvt_pk_bf16_f32 v106, v68, v69
    v_cvt_pk_bf16_f32 v107, v70, v71
    ds_write_b128 v9, v[104:107] offset:2048
    ds_write_b32 v7, v5 offset:8
K2_nod2:
    s_add_u32 s52, s49, 3
    s_and_b32 s52, s52, 7
    s_lshl_b32 s52, s52, 16
    s_add_u32 s52, s52, s54
    s_waitcnt vmcnt(12)
    buffer_load_dwordx4 v[192:195], v1, s[12:15], s52 offen offset:0
    buffer_load_dwordx4 v[196:199], v1, s[12:15], s52 offen offset:1024
    buffer_load_dwordx4 v[200:203], v1, s[12:15], s52 offen offset:2048
    buffer_load_dwordx4 v[204:207], v1, s[12:15], s52 offen offset:3072
    s_add_u32 s52, s52, 4096
    s_waitcnt vmcnt(12)
    buffer_load_dwordx4 v[208:211], v1, s[12:15], s52 offen offset:0
    buffer_load_dwordx4 v[212:215], v1, s[12:15], s52 offen offset:1024
    buffer_load_dwordx4 v[216:219], v1, s[12:15], s52 offen offset:2048
    buffer_load_dwordx4 v[220:223], v1, s[12:15], s52 offen offset:3072
    s_add_u32 s52, s52, 4096
    s_waitcnt vmcnt(12)
    buffer_load_dwordx4 v[224:227], v1, s[12:15], s52 offen offset:0
    buffer_load_dwordx4 v[228:231], v1, s[12:15], s52 offen offset:1024
    buffer_load_dwordx4 v[232:235], v1, s[12:15], s52 offen offset:2048
    buffer_load_dwordx4 v[236:239], v1, s[12:15], s52 offen offset:3072
    s_add_u32 s52, s52, 4096
    s_waitcnt vmcnt(12)
    buffer_load_dwordx4 v[240:243], v1, s[12:15], s52 offen offset:0
    buffer_load_dwordx4 v[244:247], v1, s[12:15], s52 offen offset:1024
    buffer_load_dwordx4 v[248:251], v1, s[12:15], s52 offen offset:2048
    buffer_load_dwordx4 v[252:255], v1, s[12:15], s52 offen offset:3072
    s_mov_b32 s60, 0
K2_spin_A2:
    ds_read_b32 v64, v7 offset:8
    s_waitcnt lgkmcnt(0)
    v_cmp_eq_u32 vcc, 0, v64
    s_cbranch_vccz K2_spun_A2
    s_sleep 4
    s_add_u32 s60, s60, 1
    s_cmp_lt_u32 s60, 0x400000
    s_cbranch_scc1 K2_spin_A2
K2_spun_A2:
    ds_read_b128 v[104:107], v9 offset:2048
    s_waitcnt vmcnt(16) lgkmcnt(0)
    s_setprio 0
    v_smfmac_f32_16x16x64_bf16 v[16:19], v[104:107], v[128:135], v2
    v_smfmac_f32_16x16x64_bf16 v[20:23], v[104:107], v[136:143], v2
    v_smfmac_f32_16x16x64_bf16 v[24:27], v[104:107], v[144:151], v2
    v_smfmac_f32_16x16x64_bf16 v[28:31], v[104:107], v[152:159], v2
    v_smfmac_f32_16x16x64_bf16 v[32:35], v[104:107], v[160:167], v2
    v_smfmac_f32_16x16x64_bf16 v[36:39], v[104:107], v[168:175], v2
    v_smfmac_f32_16x16x64_bf16 v[40:43], v[104:107], v[176:183], v2
    v_smfmac_f32_16x16x64_bf16 v[44:47], v[104:107], v[184:191], v2
    s_setprio 2
    s_cmp_eq_u32 s46, 3
    s_cbranch_scc0 K2_nod3
    s_mov_b32 s60, 0
K2_spin_P3:
    ds_read_b32 v64, v6 offset:7680
    s_waitcnt lgkmcnt(0)
    v_cmp_eq_u32 vcc, 0, v64
    s_cbranch_vccz K2_spun_P3
    s_sleep 4
    s_add_u32 s60, s60, 1
    s_cmp_lt_u32 s60, 0x400000
    s_cbranch_scc1 K2_spin_P3
K2_spun_P3:
    ds_read2st64_b32 v[96:97], v8 offset0:38 offset1:118
    ds_read2st64_b32 v[98:99], v110 offset0:38 offset1:118
    ds_read2st64_b32 v[64:65], v8 offset0:30 offset1:31
    ds_read2st64_b32 v[66:67], v8 offset0:32 offset1:33
    ds_read2st64_b32 v[68:69], v8 offset0:34 offset1:35
    ds_read2st64_b32 v[70:71], v8 offset0:36 offset1:37
    ds_read2st64_b32 v[72:73], v8 offset0:110 offset1:111
    ds_read2st64_b32 v[74:75], v8 offset0:112 offset1:113
    ds_read2st64_b32 v[76:77], v8 offset0:114 offset1:115
    ds_read2st64_b32 v[78:79], v8 offset0:116 offset1:117
    ds_read2st64_b32 v[80:81], v110 offset0:30 offset1:31
    ds_read2st64_b32 v[82:83], v110 offset0:32 offset1:33
    ds_read2st64_b32 v[84:85], v110 offset0:34 offset1:35
    ds_read2st64_b32 v[86:87], v110 offset0:36 offset1:37
    s_waitcnt lgkmcnt(8)
    ds_read2st64_b32 v[88:89], v110 offset0:110 offset1:111
    ds_read2st64_b32 v[90:91], v110 offset0:112 offset1:113
    ds_read2st64_b32 v[92:93], v110 offset0:114 offset1:115
    ds_read2st64_b32 v[94:95], v110 offset0:116 offset1:117
    s_waitcnt lgkmcnt(0)
    v_pk_add_f32 v[96:97], v[96:97], v[98:99]
    v_pk_add_f32 v[64:65], v[64:65], v[72:73]
    v_pk_add_f32 v[66:67], v[66:67], v[74:75]
    v_pk_add_f32 v[68:69], v[68:69], v[76:77]
    v_pk_add_f32 v[70:71], v[70:71], v[78:79]
    v_add_f32 v96, v96, v97
    v_pk_add_f32 v[80:81], v[80:81], v[88:89]
    v_pk_add_f32 v[82:83], v[82:83], v[90:91]
    v_pk_add_f32 v[84:85], v[84:85], v[92:93]
    v_pk_add_f32 v[86:87], v[86:87], v[94:95]
    v_rcp_f32 v98, v96
    v_subrev_u32 v96, 0x2f800000, v96
    v_cmp_lt_u32 vcc, 0x4c000000, v96
    v_pk_add_f32 v[64:65], v[64:65], v[80:81]
    v_pk_add_f32 v[66:67], v[66:67], v[82:83]
    v_pk_add_f32 v[68:69], v[68:69], v[84:85]
    v_pk_add_f32 v[70:71], v[70:71], v[86:87]
    s_or_b64 s[62:63], s[62:63], vcc
    v_pk_mul_f32 v[64:65], v[64:65], v[98:99] op_sel_hi:[1,0]
    v_pk_mul_f32 v[66:67], v[66:67], v[98:99] op_sel_hi:[1,0]
    v_pk_mul_f32 v[68:69], v[68:69], v[98:99] op_sel_hi:[1,0]
    v_pk_mul_f32 v[70:71], v[70:71], v[98:99] op_sel_hi:[1,0]
    v_cvt_pk_bf16_f32 v104, v64, v65
    v_cvt_pk_bf16_f32 v105, v66, v67
    v_cvt_pk_bf16_f32 v106, v68, v69
    v_cvt_pk_bf16_f32 v107, v70, v71
    ds_write_b128 v9, v[104:107] offset:3072
    ds_write_b32 v7, v5 offset:12
K2_nod3:
    s_add_u32 s52, s49, 4
    s_and_b32 s52, s52, 7
    s_lshl_b32 s52, s52, 16
    s_add_u32 s52, s52, s54
    s_waitcnt vmcnt(12)
    buffer_load_dwordx4 v[128:131], v1, s[12:15], s52 offen offset:0
    buffer_load_dwordx4 v[132:135], v1, s[12:15], s52 offen offset:1024
    buffer_load_dwordx4 v[136:139], v1, s[12:15], s52 offen offset:2048
    buffer_load_dwordx4 v[140:143], v1, s[12:15], s52 offen offset:3072
    s_add_u32 s52, s52, 4096
    s_waitcnt vmcnt(12)
    buffer_load_dwordx4 v[144:147], v1, s[12:15], s52 offen offset:0
    buffer_load_dwordx4 v[148:151], v1, s[12:15], s52 offen offset:1024
    buffer_load_dwordx4 v[152:155], v1, s[12:15], s52 offen offset:2048
    buffer_load_dwordx4 v[156:159], v1, s[12:15], s52 offen offset:3072
    s_add_u32 s52, s52, 4096
    s_waitcnt vmcnt(12)
    buffer_load_dwordx4 v[160:163], v1, s[12:15], s52 offen offset:0
    buffer_load_dwordx4 v[164:167], v1, s[12:15], s52 offen offset:1024
    buffer_load_dwordx4 v[168:171], v1, s[12:15], s52 offen offset:2048
    buffer_load_dwordx4 v[172:175], v1, s[12:15], s52 offen offset:3072
    s_add_u32 s52, s52, 4096
    s_waitcnt vmcnt(12)
    buffer_load_dwordx4 v[176:179], v1, s[12:15], s52 offen offset:0
    buffer_load_dwordx4 v[180:183], v1, s[12:15], s52 offen offset:1024
    buffer_load_dwordx4 v[184:187], v1, s[12:15], s52 offen offset:2048
    buffer_load_dwordx4 v[188:191], v1, s[12:15], s52 offen offset:3072
    s_mov_b32 s60, 0
K2_spin_A3:
    ds_read_b32 v64, v7 offset:12
    s_waitcnt lgkmcnt(0)
    v_cmp_eq_u32 vcc, 0, v64
    s_cbranch_vccz K2_spun_A3
    s_sleep 4
    s_add_u32 s60, s60, 1
    s_cmp_lt_u32 s60, 0x400000
    s_cbranch_scc1 K2_spin_A3
K2_spun_A3:
    ds_read_b128 v[104:107], v9 offset:3072
    s_waitcnt vmcnt(16) lgkmcnt(0)
    s_setprio 0
    v_smfmac_f32_16x16x64_bf16 v[16:19], v[104:107], v[192:199], v2
    v_smfmac_f32_16x16x64_bf16 v[20:23], v[104:107], v[200:207], v2
    v_smfmac_f32_16x16x64_bf16 v[24:27], v[104:107], v[208:215], v2
    v_smfmac_f32_16x16x64_bf16 v[28:31], v[104:107], v[216:223], v2
    v_smfmac_f32_16x16x64_bf16 v[32:35], v[104:107], v[224:231], v2
    v_smfmac_f32_16x16x64_bf16 v[36:39], v[104:107], v[232:239], v2
    v_smfmac_f32_16x16x64_bf16 v[40:43], v[104:107], v[240:247], v2
    v_smfmac_f32_16x16x64_bf16 v[44:47], v[104:107], v[248:255], v2
    s_setprio 2
    s_cmp_eq_u32 s46, 0
    s_cbranch_scc0 K2_nod4
    s_mov_b32 s60, 0
K2_spin_P4:
    ds_read_b32 v64, v6 offset:10240
    s_waitcnt lgkmcnt(0)
    v_cmp_eq_u32 vcc, 0, v64
    s_cbranch_vccz K2_spun_P4
    s_sleep 4
    s_add_u32 s60, s60, 1
    s_cmp_lt_u32 s60, 0x400000
    s_cbranch_scc1 K2_spin_P4
K2_spun_P4:
    ds_read2st64_b32 v[96:97], v8 offset0:48 offset1:128
    ds_read2st64_b32 v[98:99], v110 offset0:48 offset1:128
    ds_read2st64_b32 v[64:65], v8 offset0:40 offset1:41
    ds_read2st64_b32 v[66:67], v8 offset0:42 offset1:43
    ds_read2st64_b32 v[68:69], v8 offset0:44 offset1:45
    ds_read2st64_b32 v[70:71], v8 offset0:46 offset1:47
    ds_read2st64_b32 v[72:73], v8 offset0:120 offset1:121
    ds_read2st64_b32 v[74:75], v8 offset0:122 offset1:123
    ds_read2st64_b32 v[76:77], v8 offset0:124 offset1:125
    ds_read2st64_b32 v[78:79], v8 offset0:126 offset1:127
    ds_read2st64_b32 v[80:81], v110 offset0:40 offset1:41
    ds_read2st64_b32 v[82:83], v110 offset0:42 offset1:43
    ds_read2st64_b32 v[84:85], v110 offset0:44 offset1:45
    ds_read2st64_b32 v[86:87], v110 offset0:46 offset1:47
    s_waitcnt lgkmcnt(8)
    ds_read2st64_b32 v[88:89], v110 offset0:120 offset1:121
    ds_read2st64_b32 v[90:91], v110 offset0:122 offset1:123
    ds_read2st64_b32 v[92:93], v110 offset0:124 offset1:125
    ds_read2st64_b32 v[94:95], v110 offset0:126 offset1:127
    s_waitcnt lgkmcnt(0)
    v_pk_add_f32 v[96:97], v[96:97], v[98:99]
    v_pk_add_f32 v[64:65], v[64:65], v[72:73]
    v_pk_add_f32 v[66:67], v[66:67], v[74:75]
    v_pk_add_f32 v[68:69], v[68:69], v[76:77]
    v_pk_add_f32 v[70:71], v[70:71], v[78:79]
    v_add_f32 v96, v96, v97
    v_pk_add_f32 v[80:81], v[80:81], v[88:89]
    v_pk_add_f32 v[82:83], v[82:83], v[90:91]
    v_pk_add_f32 v[84:85], v[84:85], v[92:93]
    v_pk_add_f32 v[86:87], v[86:87], v[94:95]
    v_rcp_f32 v98, v96
    v_subrev_u32 v96, 0x2f800000, v96
    v_cmp_lt_u32 vcc, 0x4c000000, v96
    v_pk_add_f32 v[64:65], v[64:65], v[80:81]
    v_pk_add_f32 v[66:67], v[66:67], v[82:83]
    v_pk_add_f32 v[68:69], v[68:69], v[84:85]
    v_pk_add_f32 v[70:71], v[70:71], v[86:87]
    s_or_b64 s[62:63], s[62:63], vcc
    v_pk_mul_f32 v[64:65], v[64:65], v[98:99] op_sel_hi:[1,0]
    v_pk_mul_f32 v[66:67], v[66:67], v[98:99] op_sel_hi:[1,0]
    v_pk_mul_f32 v[68:69], v[68:69], v[98:99] op_sel_hi:[1,0]
    v_pk_mul_f32 v[70:71], v[70:71], v[98:99] op_sel_hi:[1,0]
    v_cvt_pk_bf16_f32 v104, v64, v65
    v_cvt_pk_bf16_f32 v105, v66, v67
    v_cvt_pk_bf16_f32 v106, v68, v69
    v_cvt_pk_bf16_f32 v107, v70, v71
    ds_write_b128 v9, v[104:107] offset:4096
    ds_write_b32 v7, v5 offset:16
K2_nod4:
    s_lshl_b32 s55, s41, 13
    s_lshl_b32 s53, s46, 8
    s_add_u32 s55, s55, s53
    v_lshrrev_b32 v13, 4, v0
    v_lshlrev_b32 v13, 3, v13
    s_lshl_b32 s52, s41, 5
    s_add_u32 s52, s52, 2752512
    buffer_load_dwordx2 v[10:11], v13, s[12:15], s52 offen
    buffer_load_dwordx4 v[112:115], v3, s[8:11], s55 offen offset:0
    buffer_load_dwordx4 v[116:119], v3, s[8:11], s55 offen offset:1024
    s_add_u32 s52, s49, 5
    s_and_b32 s52, s52, 7
    s_lshl_b32 s52, s52, 16
    s_add_u32 s52, s52, s54
    s_waitcnt vmcnt(12)
    buffer_load_dwordx4 v[192:195], v1, s[12:15], s52 offen offset:0
    buffer_load_dwordx4 v[196:199], v1, s[12:15], s52 offen offset:1024
    buffer_load_dwordx4 v[200:203], v1, s[12:15], s52 offen offset:2048
    buffer_load_dwordx4 v[204:207], v1, s[12:15], s52 offen offset:3072
    s_add_u32 s52, s52, 4096
    s_waitcnt vmcnt(12)
    buffer_load_dwordx4 v[208:211], v1, s[12:15], s52 offen offset:0
    buffer_load_dwordx4 v[212:215], v1, s[12:15], s52 offen offset:1024
    buffer_load_dwordx4 v[216:219], v1, s[12:15], s52 offen offset:2048
    buffer_load_dwordx4 v[220:223], v1, s[12:15], s52 offen offset:3072
    s_add_u32 s52, s52, 4096
    s_waitcnt vmcnt(12)
    buffer_load_dwordx4 v[224:227], v1, s[12:15], s52 offen offset:0
    buffer_load_dwordx4 v[228:231], v1, s[12:15], s52 offen offset:1024
    buffer_load_dwordx4 v[232:235], v1, s[12:15], s52 offen offset:2048
    buffer_load_dwordx4 v[236:239], v1, s[12:15], s52 offen offset:3072
    s_add_u32 s52, s52, 4096
    s_waitcnt vmcnt(12)
    buffer_load_dwordx4 v[240:243], v1, s[12:15], s52 offen offset:0
    buffer_load_dwordx4 v[244:247], v1, s[12:15], s52 offen offset:1024
    buffer_load_dwordx4 v[248:251], v1, s[12:15], s52 offen offset:2048
    buffer_load_dwordx4 v[252:255], v1, s[12:15], s52 offen offset:3072
    s_waitcnt vmcnt(16)
    v_lshlrev_b32 v48, 16, v112
    v_and_b32 v50, 0xffff0000, v112
    v_lshlrev_b32 v52, 16, v113
    v_and_b32 v54, 0xffff0000, v113
    v_lshlrev_b32 v56, 16, v114
    v_and_b32 v58, 0xffff0000, v114
    v_lshlrev_b32 v60, 16, v115
    v_and_b32 v62, 0xffff0000, v115
    v_lshlrev_b32 v49, 16, v116
    v_and_b32 v51, 0xffff0000, v116
    v_lshlrev_b32 v53, 16, v117
    v_and_b32 v55, 0xffff0000, v117
    v_lshlrev_b32 v57, 16, v118
    v_and_b32 v59, 0xffff0000, v118
    v_lshlrev_b32 v61, 16, v119
    v_and_b32 v63, 0xffff0000, v119
    s_lshr_b32 s52, s42, 3
    s_cmp_eq_u32 s52, s41
    s_cbranch_scc1 K2_owner
K2_owned:
    v_pk_add_f32 v[12:13], v[10:11], 1.0 op_sel_hi:[1,0] neg_lo:[1,0] neg_hi:[1,0]
    v_pk_mul_f32 v[48:49], v[48:49], v[12:13]
    v_pk_mul_f32 v[50:51], v[50:51], v[12:13]
    v_pk_mul_f32 v[52:53], v[52:53], v[12:13]
    v_pk_mul_f32 v[54:55], v[54:55], v[12:13]
    v_pk_mul_f32 v[56:57], v[56:57], v[12:13]
    v_pk_mul_f32 v[58:59], v[58:59], v[12:13]
    v_pk_mul_f32 v[60:61], v[60:61], v[12:13]
    v_pk_mul_f32 v[62:63], v[62:63], v[12:13]
    s_mov_b32 s60, 0
K2_spin_A4:
    ds_read_b32 v64, v7 offset:16
    s_waitcnt lgkmcnt(0)
    v_cmp_eq_u32 vcc, 0, v64
    s_cbranch_vccz K2_spun_A4
    s_sleep 4
    s_add_u32 s60, s60, 1
    s_cmp_lt_u32 s60, 0x400000
    s_cbranch_scc1 K2_spin_A4
K2_spun_A4:
    ds_read_b128 v[104:107], v9 offset:4096
    s_waitcnt vmcnt(16) lgkmcnt(0)
    s_setprio 0
    v_smfmac_f32_16x16x64_bf16 v[16:19], v[104:107], v[128:135], v2
    v_smfmac_f32_16x16x64_bf16 v[20:23], v[104:107], v[136:143], v2
    v_smfmac_f32_16x16x64_bf16 v[24:27], v[104:107], v[144:151], v2
    v_smfmac_f32_16x16x64_bf16 v[28:31], v[104:107], v[152:159], v2
    v_smfmac_f32_16x16x64_bf16 v[32:35], v[104:107], v[160:167], v2
    v_smfmac_f32_16x16x64_bf16 v[36:39], v[104:107], v[168:175], v2
    v_smfmac_f32_16x16x64_bf16 v[40:43], v[104:107], v[176:183], v2
    v_smfmac_f32_16x16x64_bf16 v[44:47], v[104:107], v[184:191], v2
    s_setprio 2
    s_cmp_eq_u32 s46, 1
    s_cbranch_scc0 K2_nod5
    s_mov_b32 s60, 0
K2_spin_P5:
    ds_read_b32 v64, v6 offset:12800
    s_waitcnt lgkmcnt(0)
    v_cmp_eq_u32 vcc, 0, v64
    s_cbranch_vccz K2_spun_P5
    s_sleep 4
    s_add_u32 s60, s60, 1
    s_cmp_lt_u32 s60, 0x400000
    s_cbranch_scc1 K2_spin_P5
K2_spun_P5:
    ds_read2st64_b32 v[96:97], v8 offset0:58 offset1:138
    ds_read2st64_b32 v[98:99], v110 offset0:58 offset1:138
    ds_read2st64_b32 v[64:65], v8 offset0:50 offset1:51
    ds_read2st64_b32 v[66:67], v8 offset0:52 offset1:53
    ds_read2st64_b32 v[68:69], v8 offset0:54 offset1:55
    ds_read2st64_b32 v[70:71], v8 offset0:56 offset1:57
    ds_read2st64_b32 v[72:73], v8 offset0:130 offset1:131
    ds_read2st64_b32 v[74:75], v8 offset0:132 offset1:133
    ds_read2st64_b32 v[76:77], v8 offset0:134 offset1:135
    ds_read2st64_b32 v[78:79], v8 offset0:136 offset1:137
    ds_read2st64_b32 v[80:81], v110 offset0:50 offset1:51
    ds_read2st64_b32 v[82:83], v110 offset0:52 offset1:53
    ds_read2st64_b32 v[84:85], v110 offset0:54 offset1:55
    ds_read2st64_b32 v[86:87], v110 offset0:56 offset1:57
    s_waitcnt lgkmcnt(8)
    ds_read2st64_b32 v[88:89], v110 offset0:130 offset1:131
    ds_read2st64_b32 v[90:91], v110 offset0:132 offset1:133
    ds_read2st64_b32 v[92:93], v110 offset0:134 offset1:135
    ds_read2st64_b32 v[94:95], v110 offset0:136 offset1:137
    s_waitcnt lgkmcnt(0)
    v_pk_add_f32 v[96:97], v[96:97], v[98:99]
    v_pk_add_f32 v[64:65], v[64:65], v[72:73]
    v_pk_add_f32 v[66:67], v[66:67], v[74:75]
    v_pk_add_f32 v[68:69], v[68:69], v[76:77]
    v_pk_add_f32 v[70:71], v[70:71], v[78:79]
    v_add_f32 v96, v96, v97
    v_pk_add_f32 v[80:81], v[80:81], v[88:89]
    v_pk_add_f32 v[82:83], v[82:83], v[90:91]
    v_pk_add_f32 v[84:85], v[84:85], v[92:93]
    v_pk_add_f32 v[86:87], v[86:87], v[94:95]
    v_rcp_f32 v98, v96
    v_subrev_u32 v96, 0x2f800000, v96
    v_cmp_lt_u32 vcc, 0x4c000000, v96
    v_pk_add_f32 v[64:65], v[64:65], v[80:81]
    v_pk_add_f32 v[66:67], v[66:67], v[82:83]
    v_pk_add_f32 v[68:69], v[68:69], v[84:85]
    v_pk_add_f32 v[70:71], v[70:71], v[86:87]
    s_or_b64 s[62:63], s[62:63], vcc
    v_pk_mul_f32 v[64:65], v[64:65], v[98:99] op_sel_hi:[1,0]
    v_pk_mul_f32 v[66:67], v[66:67], v[98:99] op_sel_hi:[1,0]
    v_pk_mul_f32 v[68:69], v[68:69], v[98:99] op_sel_hi:[1,0]
    v_pk_mul_f32 v[70:71], v[70:71], v[98:99] op_sel_hi:[1,0]
    v_cvt_pk_bf16_f32 v104, v64, v65
    v_cvt_pk_bf16_f32 v105, v66, v67
    v_cvt_pk_bf16_f32 v106, v68, v69
    v_cvt_pk_bf16_f32 v107, v70, v71
    ds_write_b128 v9, v[104:107] offset:5120
    ds_write_b32 v7, v5 offset:20
K2_nod5:
    s_add_u32 s52, s49, 6
    s_and_b32 s52, s52, 7
    s_lshl_b32 s52, s52, 16
    s_add_u32 s52, s52, s54
    s_waitcnt vmcnt(12)
    buffer_load_dwordx4 v[128:131], v1, s[12:15], s52 offen offset:0
    buffer_load_dwordx4 v[132:135], v1, s[12:15], s52 offen offset:1024
    buffer_load_dwordx4 v[136:139], v1, s[12:15], s52 offen offset:2048
    buffer_load_dwordx4 v[140:143], v1, s[12:15], s52 offen offset:3072
    s_add_u32 s52, s52, 4096
    s_waitcnt vmcnt(12)
    buffer_load_dwordx4 v[144:147], v1, s[12:15], s52 offen offset:0
    buffer_load_dwordx4 v[148:151], v1, s[12:15], s52 offen offset:1024
    buffer_load_dwordx4 v[152:155], v1, s[12:15], s52 offen offset:2048
    buffer_load_dwordx4 v[156:159], v1, s[12:15], s52 offen offset:3072
    s_add_u32 s52, s52, 4096
    s_waitcnt vmcnt(12)
    buffer_load_dwordx4 v[160:163], v1, s[12:15], s52 offen offset:0
    buffer_load_dwordx4 v[164:167], v1, s[12:15], s52 offen offset:1024
    buffer_load_dwordx4 v[168:171], v1, s[12:15], s52 offen offset:2048
    buffer_load_dwordx4 v[172:175], v1, s[12:15], s52 offen offset:3072
    s_add_u32 s52, s52, 4096
    s_waitcnt vmcnt(12)
    buffer_load_dwordx4 v[176:179], v1, s[12:15], s52 offen offset:0
    buffer_load_dwordx4 v[180:183], v1, s[12:15], s52 offen offset:1024
    buffer_load_dwordx4 v[184:187], v1, s[12:15], s52 offen offset:2048
    buffer_load_dwordx4 v[188:191], v1, s[12:15], s52 offen offset:3072
    s_mov_b32 s60, 0
K2_spin_A5:
    ds_read_b32 v64, v7 offset:20
    s_waitcnt lgkmcnt(0)
    v_cmp_eq_u32 vcc, 0, v64
    s_cbranch_vccz K2_spun_A5
    s_sleep 4
    s_add_u32 s60, s60, 1
    s_cmp_lt_u32 s60, 0x400000
    s_cbranch_scc1 K2_spin_A5
K2_spun_A5:
    ds_read_b128 v[104:107], v9 offset:5120
    s_waitcnt vmcnt(16) lgkmcnt(0)
    s_setprio 0
    v_smfmac_f32_16x16x64_bf16 v[16:19], v[104:107], v[192:199], v2
    v_smfmac_f32_16x16x64_bf16 v[20:23], v[104:107], v[200:207], v2
    v_smfmac_f32_16x16x64_bf16 v[24:27], v[104:107], v[208:215], v2
    v_smfmac_f32_16x16x64_bf16 v[28:31], v[104:107], v[216:223], v2
    v_smfmac_f32_16x16x64_bf16 v[32:35], v[104:107], v[224:231], v2
    v_smfmac_f32_16x16x64_bf16 v[36:39], v[104:107], v[232:239], v2
    v_smfmac_f32_16x16x64_bf16 v[40:43], v[104:107], v[240:247], v2
    v_smfmac_f32_16x16x64_bf16 v[44:47], v[104:107], v[248:255], v2
    s_setprio 2
    s_add_u32 s52, s49, 7
    s_and_b32 s52, s52, 7
    s_lshl_b32 s52, s52, 16
    s_add_u32 s52, s52, s54
    s_waitcnt vmcnt(12)
    buffer_load_dwordx4 v[192:195], v1, s[12:15], s52 offen offset:0
    buffer_load_dwordx4 v[196:199], v1, s[12:15], s52 offen offset:1024
    buffer_load_dwordx4 v[200:203], v1, s[12:15], s52 offen offset:2048
    buffer_load_dwordx4 v[204:207], v1, s[12:15], s52 offen offset:3072
    s_add_u32 s52, s52, 4096
    s_waitcnt vmcnt(12)
    buffer_load_dwordx4 v[208:211], v1, s[12:15], s52 offen offset:0
    buffer_load_dwordx4 v[212:215], v1, s[12:15], s52 offen offset:1024
    buffer_load_dwordx4 v[216:219], v1, s[12:15], s52 offen offset:2048
    buffer_load_dwordx4 v[220:223], v1, s[12:15], s52 offen offset:3072
    s_add_u32 s52, s52, 4096
    s_waitcnt vmcnt(12)
    buffer_load_dwordx4 v[224:227], v1, s[12:15], s52 offen offset:0
    buffer_load_dwordx4 v[228:231], v1, s[12:15], s52 offen offset:1024
    buffer_load_dwordx4 v[232:235], v1, s[12:15], s52 offen offset:2048
    buffer_load_dwordx4 v[236:239], v1, s[12:15], s52 offen offset:3072
    s_add_u32 s52, s52, 4096
    s_waitcnt vmcnt(12)
    buffer_load_dwordx4 v[240:243], v1, s[12:15], s52 offen offset:0
    buffer_load_dwordx4 v[244:247], v1, s[12:15], s52 offen offset:1024
    buffer_load_dwordx4 v[248:251], v1, s[12:15], s52 offen offset:2048
    buffer_load_dwordx4 v[252:255], v1, s[12:15], s52 offen offset:3072
    s_cmp_eq_u32 s46, 2
    s_cbranch_scc0 K2_nod6
    s_mov_b32 s60, 0
K2_spin_P6:
    ds_read_b32 v64, v6 offset:15360
    s_waitcnt lgkmcnt(0)
    v_cmp_eq_u32 vcc, 0, v64
    s_cbranch_vccz K2_spun_P6
    s_sleep 4
    s_add_u32 s60, s60, 1
    s_cmp_lt_u32 s60, 0x400000
    s_cbranch_scc1 K2_spin_P6
K2_spun_P6:
    ds_read2st64_b32 v[96:97], v8 offset0:68 offset1:148
    ds_read2st64_b32 v[98:99], v110 offset0:68 offset1:148
    ds_read2st64_b32 v[64:65], v8 offset0:60 offset1:61
    ds_read2st64_b32 v[66:67], v8 offset0:62 offset1:63
    ds_read2st64_b32 v[68:69], v8 offset0:64 offset1:65
    ds_read2st64_b32 v[70:71], v8 offset0:66 offset1:67
    ds_read2st64_b32 v[72:73], v8 offset0:140 offset1:141
    ds_read2st64_b32 v[74:75], v8 offset0:142 offset1:143
    ds_read2st64_b32 v[76:77], v8 offset0:144 offset1:145
    ds_read2st64_b32 v[78:79], v8 offset0:146 offset1:147
    ds_read2st64_b32 v[80:81], v110 offset0:60 offset1:61
    ds_read2st64_b32 v[82:83], v110 offset0:62 offset1:63
    ds_read2st64_b32 v[84:85], v110 offset0:64 offset1:65
    ds_read2st64_b32 v[86:87], v110 offset0:66 offset1:67
    s_waitcnt lgkmcnt(8)
    ds_read2st64_b32 v[88:89], v110 offset0:140 offset1:141
    ds_read2st64_b32 v[90:91], v110 offset0:142 offset1:143
    ds_read2st64_b32 v[92:93], v110 offset0:144 offset1:145
    ds_read2st64_b32 v[94:95], v110 offset0:146 offset1:147
    s_waitcnt lgkmcnt(0)
    v_pk_add_f32 v[96:97], v[96:97], v[98:99]
    v_pk_add_f32 v[64:65], v[64:65], v[72:73]
    v_pk_add_f32 v[66:67], v[66:67], v[74:75]
    v_pk_add_f32 v[68:69], v[68:69], v[76:77]
    v_pk_add_f32 v[70:71], v[70:71], v[78:79]
    v_add_f32 v96, v96, v97
    v_pk_add_f32 v[80:81], v[80:81], v[88:89]
    v_pk_add_f32 v[82:83], v[82:83], v[90:91]
    v_pk_add_f32 v[84:85], v[84:85], v[92:93]
    v_pk_add_f32 v[86:87], v[86:87], v[94:95]
    v_rcp_f32 v98, v96
    v_subrev_u32 v96, 0x2f800000, v96
    v_cmp_lt_u32 vcc, 0x4c000000, v96
    v_pk_add_f32 v[64:65], v[64:65], v[80:81]
    v_pk_add_f32 v[66:67], v[66:67], v[82:83]
    v_pk_add_f32 v[68:69], v[68:69], v[84:85]
    v_pk_add_f32 v[70:71], v[70:71], v[86:87]
    s_or_b64 s[62:63], s[62:63], vcc
    v_pk_mul_f32 v[64:65], v[64:65], v[98:99] op_sel_hi:[1,0]
    v_pk_mul_f32 v[66:67], v[66:67], v[98:99] op_sel_hi:[1,0]
    v_pk_mul_f32 v[68:69], v[68:69], v[98:99] op_sel_hi:[1,0]
    v_pk_mul_f32 v[70:71], v[70:71], v[98:99] op_sel_hi:[1,0]
    v_cvt_pk_bf16_f32 v104, v64, v65
    v_cvt_pk_bf16_f32 v105, v66, v67
    v_cvt_pk_bf16_f32 v106, v68, v69
    v_cvt_pk_bf16_f32 v107, v70, v71
    ds_write_b128 v9, v[104:107] offset:6144
    ds_write_b32 v7, v5 offset:24
K2_nod6:
    s_mov_b32 s60, 0
K2_spin_A6:
    ds_read_b32 v64, v7 offset:24
    s_waitcnt lgkmcnt(0)
    v_cmp_eq_u32 vcc, 0, v64
    s_cbranch_vccz K2_spun_A6
    s_sleep 4
    s_add_u32 s60, s60, 1
    s_cmp_lt_u32 s60, 0x400000
    s_cbranch_scc1 K2_spin_A6
K2_spun_A6:
    ds_read_b128 v[104:107], v9 offset:6144
    s_waitcnt vmcnt(16) lgkmcnt(0)
    s_setprio 0
    v_smfmac_f32_16x16x64_bf16 v[16:19], v[104:107], v[128:135], v2
    v_smfmac_f32_16x16x64_bf16 v[20:23], v[104:107], v[136:143], v2
    v_smfmac_f32_16x16x64_bf16 v[24:27], v[104:107], v[144:151], v2
    v_smfmac_f32_16x16x64_bf16 v[28:31], v[104:107], v[152:159], v2
    v_smfmac_f32_16x16x64_bf16 v[32:35], v[104:107], v[160:167], v2
    v_smfmac_f32_16x16x64_bf16 v[36:39], v[104:107], v[168:175], v2
    v_smfmac_f32_16x16x64_bf16 v[40:43], v[104:107], v[176:183], v2
    v_smfmac_f32_16x16x64_bf16 v[44:47], v[104:107], v[184:191], v2
    s_setprio 2
K2_lasttile:
    s_lshl_b32 s52, s46, 9
    v_lshlrev_b32 v12, 2, v0
    v_add_u32 v12, 8192, v12
    v_add_u32 v13, 40960, v12
    v_add_u32 v14, s52, v12
    v_add_u32 v15, s52, v13
    s_waitcnt vmcnt(0)
    s_barrier
    ds_read2st64_b32 v[72:73], v12 offset0:78 offset1:158
    ds_read2st64_b32 v[74:75], v13 offset0:78 offset1:158
    ds_read2st64_b32 v[64:65], v14 offset0:70 offset1:71
    ds_read2st64_b32 v[66:67], v14 offset0:150 offset1:151
    ds_read2st64_b32 v[68:69], v15 offset0:70 offset1:71
    ds_read2st64_b32 v[70:71], v15 offset0:150 offset1:151
    s_waitcnt lgkmcnt(4)
    v_pk_add_f32 v[72:73], v[72:73], v[74:75]
    v_add_f32 v72, v72, v73
    v_rcp_f32 v74, v72
    s_waitcnt lgkmcnt(0)
    v_pk_add_f32 v[64:65], v[64:65], v[66:67]
    v_pk_add_f32 v[68:69], v[68:69], v[70:71]
    v_pk_add_f32 v[64:65], v[64:65], v[68:69]
    v_pk_mul_f32 v[64:65], v[64:65], v[74:75] op_sel_hi:[1,0]
    v_cvt_pk_bf16_f32 v64, v64, v65
    ds_write_b32 v4, v64
    v_subrev_u32 v72, 0x2f800000, v72
    v_cmp_lt_u32 vcc, 0x4c000000, v72
    s_waitcnt lgkmcnt(0)
    s_barrier
    ds_read_b128 v[104:107], v9 offset:7168
    s_or_b64 s[62:63], s[62:63], vcc
    s_waitcnt lgkmcnt(0)
    v_smfmac_f32_16x16x64_bf16 v[16:19], v[104:107], v[192:199], v2
    v_smfmac_f32_16x16x64_bf16 v[20:23], v[104:107], v[200:207], v2
    v_smfmac_f32_16x16x64_bf16 v[24:27], v[104:107], v[208:215], v2
    v_smfmac_f32_16x16x64_bf16 v[28:31], v[104:107], v[216:223], v2
    v_smfmac_f32_16x16x64_bf16 v[32:35], v[104:107], v[224:231], v2
    v_smfmac_f32_16x16x64_bf16 v[36:39], v[104:107], v[232:239], v2
    v_smfmac_f32_16x16x64_bf16 v[40:43], v[104:107], v[240:247], v2
    v_smfmac_f32_16x16x64_bf16 v[44:47], v[104:107], v[248:255], v2
    s_nop 0
    v_pk_fma_f32 v[48:49], v[10:11], v[16:17], v[48:49]
    v_pk_fma_f32 v[50:51], v[10:11], v[20:21], v[50:51]
    v_pk_fma_f32 v[52:53], v[10:11], v[24:25], v[52:53]
    v_pk_fma_f32 v[54:55], v[10:11], v[28:29], v[54:55]
    v_pk_fma_f32 v[56:57], v[10:11], v[32:33], v[56:57]
    v_pk_fma_f32 v[58:59], v[10:11], v[36:37], v[58:59]
    v_pk_fma_f32 v[60:61], v[10:11], v[40:41], v[60:61]
    v_pk_fma_f32 v[62:63], v[10:11], v[44:45], v[62:63]
    v_pk_fma_f32 v[48:49], v[10:11], v[18:19], v[48:49]
    v_pk_fma_f32 v[50:51], v[10:11], v[22:23], v[50:51]
    v_pk_fma_f32 v[52:53], v[10:11], v[26:27], v[52:53]
    v_pk_fma_f32 v[54:55], v[10:11], v[30:31], v[54:55]
    v_pk_fma_f32 v[56:57], v[10:11], v[34:35], v[56:57]
    v_pk_fma_f32 v[58:59], v[10:11], v[38:39], v[58:59]
    v_pk_fma_f32 v[60:61], v[10:11], v[42:43], v[60:61]
    v_pk_fma_f32 v[62:63], v[10:11], v[46:47], v[62:63]
    v_cvt_pk_bf16_f32 v112, v48, v50
    v_cvt_pk_bf16_f32 v113, v52, v54
    v_cvt_pk_bf16_f32 v114, v56, v58
    v_cvt_pk_bf16_f32 v115, v60, v62
    buffer_store_dwordx4 v[112:115], v3, s[16:19], s55 offen offset:0 sc1
    v_cvt_pk_bf16_f32 v116, v49, v51
    v_cvt_pk_bf16_f32 v117, v53, v55
    v_cvt_pk_bf16_f32 v118, v57, v59
    v_cvt_pk_bf16_f32 v119, v61, v63
    buffer_store_dwordx4 v[116:119], v3, s[16:19], s55 offen offset:1024 sc1
    v_pk_add_f32 v[12:13], v[16:17], v[18:19]
    v_mul_f32 v12, 0, v12
    v_fmac_f32 v12, 0, v13
    v_cmp_u_f32 vcc, v12, v12
    s_or_b64 s[62:63], s[62:63], vcc
    s_cbranch_scc0 K2_final
    ds_write_b32 v7, v5 offset:48
    s_branch K2_final
K2_owner:
    v_lshlrev_b32 v12, 7, v0
    s_mov_b32 s60, 0
K2_ypoll:
    s_mov_b32 s52, 2785280
    buffer_load_dword v64, v12, s[12:15], s52 offen sc1
    s_add_u32 s52, s52, 8192
    buffer_load_dword v65, v12, s[12:15], s52 offen sc1
    s_add_u32 s52, s52, 8192
    buffer_load_dword v66, v12, s[12:15], s52 offen sc1
    s_add_u32 s52, s52, 8192
    buffer_load_dword v67, v12, s[12:15], s52 offen sc1
    s_add_u32 s52, s52, 8192
    buffer_load_dword v68, v12, s[12:15], s52 offen sc1
    s_add_u32 s52, s52, 8192
    buffer_load_dword v69, v12, s[12:15], s52 offen sc1
    s_add_u32 s52, s52, 8192
    buffer_load_dword v70, v12, s[12:15], s52 offen sc1
    s_waitcnt vmcnt(0)
    v_min3_u32 v64, v64, v65, v66
    v_min3_u32 v67, v67, v68, v69
    v_min3_u32 v64, v64, v67, v70
    v_cmp_eq_u32 vcc, 0, v64
    s_cbranch_vccz K2_yready
    s_sleep 8
    s_add_u32 s60, s60, 1
    s_cmp_lt_u32 s60, 0x100000
    s_cbranch_scc1 K2_ypoll
K2_yready:
    v_lshlrev_b32 v12, 3, v0
    s_lshl_b32 s52, s46, 9
    v_add_u32 v14, s52, v12
    v_add_u32 v14, 153216, v14
    v_and_b32 v15, 15, v0
    v_lshl_add_u32 v15, v15, 5, s52
    v_add_u32 v15, 153216, v15
    s_add_u32 s52, s52, 2768896
    buffer_load_dwordx2 v[64:65], v12, s[12:15], s52 offen offset:0 sc1
    buffer_load_dwordx2 v[66:67], v12, s[12:15], s52 offen offset:2048 sc1
    s_add_u32 s52, s52, 4096
    buffer_load_dwordx2 v[68:69], v12, s[12:15], s52 offen offset:0 sc1
    buffer_load_dwordx2 v[70:71], v12, s[12:15], s52 offen offset:2048 sc1
    s_add_u32 s52, s52, 4096
    buffer_load_dwordx2 v[72:73], v12, s[12:15], s52 offen offset:0 sc1
    buffer_load_dwordx2 v[74:75], v12, s[12:15], s52 offen offset:2048 sc1
    s_add_u32 s52, s52, 4096
    buffer_load_dwordx2 v[76:77], v12, s[12:15], s52 offen offset:0 sc1
    buffer_load_dwordx2 v[78:79], v12, s[12:15], s52 offen offset:2048 sc1
    s_ashr_i32 s52, s48, 31
    s_not_b32 s52, s52
    s_or_b32 s52, s52, 0x80000000
    s_xor_b32 s53, s48, s52
    s_and_b32 s53, s53, 0xfffff800
    v_cvt_pk_bf16_f32 v13, s53, s53
    v_and_b32 v13, 0xffff0000, v13
    v_mul_f32 v13, 0xbfb8aa3b, v13
    v_exp_f32 v13, v13
    s_bfe_u32 s53, s42, 0x20001
    v_lshrrev_b32 v120, 4, v0
    v_add_f32 v13, 1.0, v13
    v_rcp_f32 v13, v13
    v_cmp_eq_u32 s[56:57], s53, v120
    v_cvt_pk_bf16_f32 v13, v13, v13
    v_and_b32 v13, 0xffff0000, v13
    s_waitcnt vmcnt(0)
    v_pk_add_f32 v[64:65], v[64:65], v[72:73]
    v_pk_add_f32 v[66:67], v[66:67], v[74:75]
    v_pk_add_f32 v[68:69], v[68:69], v[76:77]
    v_pk_add_f32 v[70:71], v[70:71], v[78:79]
    v_pk_add_f32 v[64:65], v[64:65], v[68:69]
    v_pk_add_f32 v[66:67], v[66:67], v[70:71]
    v_pk_add_f32 v[64:65], v[64:65], v[66:67]
    v_cvt_pk_bf16_f32 v64, v64, v65
    v_and_b32 v65, 0xffff0000, v64
    v_lshlrev_b32 v64, 16, v64
    v_mul_f32 v64, v64, v13
    v_mul_f32 v65, v65, v13
    ds_write_b64 v14, v[64:65]
    ds_read_b128 v[120:123], v15
    ds_read_b128 v[124:127], v15 offset:16
    s_waitcnt lgkmcnt(0)
    s_mov_b64 exec, s[56:57]
    s_bitcmp1_b32 s42, 0
    s_cbranch_scc1 K2_yrow1
    v_add_f32 v48, v48, v120
    v_add_f32 v50, v50, v121
    v_add_f32 v52, v52, v122
    v_add_f32 v54, v54, v123
    v_add_f32 v56, v56, v124
    v_add_f32 v58, v58, v125
    v_add_f32 v60, v60, v126
    v_add_f32 v62, v62, v127
    s_mov_b64 exec, -1
    s_branch K2_owned
K2_yrow1:
    v_add_f32 v49, v49, v120
    v_add_f32 v51, v51, v121
    v_add_f32 v53, v53, v122
    v_add_f32 v55, v55, v123
    v_add_f32 v57, v57, v124
    v_add_f32 v59, v59, v125
    v_add_f32 v61, v61, v126
    v_add_f32 v63, v63, v127
    s_mov_b64 exec, -1
    s_branch K2_owned
K2_unsafe:
    s_mov_b32 s44, 1
    s_waitcnt vmcnt(0)
    s_barrier
    v_and_b32 v13, 31, v0
    v_mul_u32_u24 v13, 2560, v13
    v_lshlrev_b32 v12, 2, v0
    v_add_u32 v12, 98304, v12
    v_mov_b32 v14, 0
    ds_write_b32 v13, v14 offset:10496
    ds_write_b32 v12, v14
    v_mov_b32 v15, 0xff800000
    ds_write_b32 v12, v15 offset:256
    ds_write_b32 v12, v15 offset:512
    ds_write_b32 v12, v15 offset:768
    ds_write_b32 v12, v15 offset:1024
    s_waitcnt lgkmcnt(0)
    s_barrier
    s_cmp_lt_u32 s40, 4
    s_cbranch_scc1 K2_maxpass
    s_barrier
    s_branch K2_project
K2_maxpass:
    v_and_b32 v13, 31, v0
    v_lshlrev_b32 v13, 2, v13
    v_add_u32 v13, 98560, v13
    v_mov_b32 v15, v1
    s_mov_b32 s55, 0
K2_maxloop:
    ds_read_b128 v[8:11], v15
    v_mov_b32 v14, 0xff800000
    s_waitcnt lgkmcnt(0)
    v_mfma_f32_32x32x16_bf16 v[32:47], v[64:67], v[8:11], 0
    s_nop 15
    v_max3_f32 v14, v32, v33, v14
    v_max3_f32 v14, v34, v35, v14
    v_max3_f32 v14, v36, v37, v14
    v_max3_f32 v14, v38, v39, v14
    v_max3_f32 v14, v40, v41, v14
    v_max3_f32 v14, v42, v43, v14
    v_max3_f32 v14, v44, v45, v14
    v_max3_f32 v14, v46, v47, v14
    v_mfma_f32_32x32x16_bf16 v[32:47], v[68:71], v[8:11], 0
    s_nop 15
    v_max3_f32 v14, v32, v33, v14
    v_max3_f32 v14, v34, v35, v14
    v_max3_f32 v14, v36, v37, v14
    v_max3_f32 v14, v38, v39, v14
    v_max3_f32 v14, v40, v41, v14
    v_max3_f32 v14, v42, v43, v14
    v_max3_f32 v14, v44, v45, v14
    v_max3_f32 v14, v46, v47, v14
    v_mfma_f32_32x32x16_bf16 v[32:47], v[72:75], v[8:11], 0
    s_nop 15
    v_max3_f32 v14, v32, v33, v14
    v_max3_f32 v14, v34, v35, v14
    v_max3_f32 v14, v36, v37, v14
    v_max3_f32 v14, v38, v39, v14
    v_max3_f32 v14, v40, v41, v14
    v_max3_f32 v14, v42, v43, v14
    v_max3_f32 v14, v44, v45, v14
    v_max3_f32 v14, v46, v47, v14
    v_mfma_f32_32x32x16_bf16 v[32:47], v[76:79], v[8:11], 0
    s_nop 15
    v_max3_f32 v14, v32, v33, v14
    v_max3_f32 v14, v34, v35, v14
    v_max3_f32 v14, v36, v37, v14
    v_max3_f32 v14, v38, v39, v14
    v_max3_f32 v14, v40, v41, v14
    v_max3_f32 v14, v42, v43, v14
    v_max3_f32 v14, v44, v45, v14
    v_max3_f32 v14, v46, v47, v14
    v_mfma_f32_32x32x16_bf16 v[32:47], v[80:83], v[8:11], 0
    s_nop 15
    v_max3_f32 v14, v32, v33, v14
    v_max3_f32 v14, v34, v35, v14
    v_max3_f32 v14, v36, v37, v14
    v_max3_f32 v14, v38, v39, v14
    v_max3_f32 v14, v40, v41, v14
    v_max3_f32 v14, v42, v43, v14
    v_max3_f32 v14, v44, v45, v14
    v_max3_f32 v14, v46, v47, v14
    v_mfma_f32_32x32x16_bf16 v[32:47], v[84:87], v[8:11], 0
    s_nop 15
    v_max3_f32 v14, v32, v33, v14
    v_max3_f32 v14, v34, v35, v14
    v_max3_f32 v14, v36, v37, v14
    v_max3_f32 v14, v38, v39, v14
    v_max3_f32 v14, v40, v41, v14
    v_max3_f32 v14, v42, v43, v14
    v_max3_f32 v14, v44, v45, v14
    v_max3_f32 v14, v46, v47, v14
    v_mfma_f32_32x32x16_bf16 v[32:47], v[88:91], v[8:11], 0
    s_nop 15
    v_max3_f32 v14, v32, v33, v14
    v_max3_f32 v14, v34, v35, v14
    v_max3_f32 v14, v36, v37, v14
    v_max3_f32 v14, v38, v39, v14
    v_max3_f32 v14, v40, v41, v14
    v_max3_f32 v14, v42, v43, v14
    v_max3_f32 v14, v44, v45, v14
    v_max3_f32 v14, v46, v47, v14
    v_mfma_f32_32x32x16_bf16 v[32:47], v[92:95], v[8:11], 0
    s_nop 15
    v_max3_f32 v14, v32, v33, v14
    v_max3_f32 v14, v34, v35, v14
    v_max3_f32 v14, v36, v37, v14
    v_max3_f32 v14, v38, v39, v14
    v_max3_f32 v14, v40, v41, v14
    v_max3_f32 v14, v42, v43, v14
    v_max3_f32 v14, v44, v45, v14
    v_max3_f32 v14, v46, v47, v14
    v_mfma_f32_32x32x16_bf16 v[32:47], v[96:99], v[8:11], 0
    s_nop 15
    v_max3_f32 v14, v32, v33, v14
    v_max3_f32 v14, v34, v35, v14
    v_max3_f32 v14, v36, v37, v14
    v_max3_f32 v14, v38, v39, v14
    v_max3_f32 v14, v40, v41, v14
    v_max3_f32 v14, v42, v43, v14
    v_max3_f32 v14, v44, v45, v14
    v_max3_f32 v14, v46, v47, v14
    v_mfma_f32_32x32x16_bf16 v[32:47], v[100:103], v[8:11], 0
    s_nop 15
    v_max3_f32 v14, v32, v33, v14
    v_max3_f32 v14, v34, v35, v14
    v_max3_f32 v14, v36, v37, v14
    v_max3_f32 v14, v38, v39, v14
    v_max3_f32 v14, v40, v41, v14
    v_max3_f32 v14, v42, v43, v14
    v_max3_f32 v14, v44, v45, v14
    v_max3_f32 v14, v46, v47, v14
    v_mfma_f32_32x32x16_bf16 v[32:47], v[104:107], v[8:11], 0
    s_nop 15
    v_max3_f32 v14, v32, v33, v14
    v_max3_f32 v14, v34, v35, v14
    v_max3_f32 v14, v36, v37, v14
    v_max3_f32 v14, v38, v39, v14
    v_max3_f32 v14, v40, v41, v14
    v_max3_f32 v14, v42, v43, v14
    v_max3_f32 v14, v44, v45, v14
    v_max3_f32 v14, v46, v47, v14
    v_mfma_f32_32x32x16_bf16 v[32:47], v[108:111], v[8:11], 0
    s_nop 15
    v_max3_f32 v14, v32, v33, v14
    v_max3_f32 v14, v34, v35, v14
    v_max3_f32 v14, v36, v37, v14
    v_max3_f32 v14, v38, v39, v14
    v_max3_f32 v14, v40, v41, v14
    v_max3_f32 v14, v42, v43, v14
    v_max3_f32 v14, v44, v45, v14
    v_max3_f32 v14, v46, v47, v14
    v_mfma_f32_32x32x16_bf16 v[32:47], v[112:115], v[8:11], 0
    s_nop 15
    v_max3_f32 v14, v32, v33, v14
    v_max3_f32 v14, v34, v35, v14
    v_max3_f32 v14, v36, v37, v14
    v_max3_f32 v14, v38, v39, v14
    v_max3_f32 v14, v40, v41, v14
    v_max3_f32 v14, v42, v43, v14
    v_max3_f32 v14, v44, v45, v14
    v_max3_f32 v14, v46, v47, v14
    v_mfma_f32_32x32x16_bf16 v[32:47], v[116:119], v[8:11], 0
    s_nop 15
    v_max3_f32 v14, v32, v33, v14
    v_max3_f32 v14, v34, v35, v14
    v_max3_f32 v14, v36, v37, v14
    v_max3_f32 v14, v38, v39, v14
    v_max3_f32 v14, v40, v41, v14
    v_max3_f32 v14, v42, v43, v14
    v_max3_f32 v14, v44, v45, v14
    v_max3_f32 v14, v46, v47, v14
    v_mfma_f32_32x32x16_bf16 v[32:47], v[120:123], v[8:11], 0
    s_nop 15
    v_max3_f32 v14, v32, v33, v14
    v_max3_f32 v14, v34, v35, v14
    v_max3_f32 v14, v36, v37, v14
    v_max3_f32 v14, v38, v39, v14
    v_max3_f32 v14, v40, v41, v14
    v_max3_f32 v14, v42, v43, v14
    v_max3_f32 v14, v44, v45, v14
    v_max3_f32 v14, v46, v47, v14
    v_mfma_f32_32x32x16_bf16 v[32:47], v[124:127], v[8:11], 0
    s_nop 15
    v_max3_f32 v14, v32, v33, v14
    v_max3_f32 v14, v34, v35, v14
    v_max3_f32 v14, v36, v37, v14
    v_max3_f32 v14, v38, v39, v14
    v_max3_f32 v14, v40, v41, v14
    v_max3_f32 v14, v42, v43, v14
    v_max3_f32 v14, v44, v45, v14
    v_max3_f32 v14, v46, v47, v14
    ds_max_f32 v13, v14
    v_add_u32 v13, 128, v13
    v_add_u32 v15, 1024, v15
    s_add_u32 s55, s55, 1
    s_cmp_lt_u32 s55, 8
    s_cbranch_scc1 K2_maxloop
    s_waitcnt lgkmcnt(0)
    s_barrier
    v_subrev_u32 v13, 1024, v13
    v_mov_b32 v15, v1
    v_lshl_add_u32 v3, v0, 2, s54
    s_mov_b32 s55, 0
K2_exactloop:
    ds_read_b128 v[8:11], v15
    ds_read_b32 v14, v13
    v_mov_b64 v[16:17], 0
    v_mov_b64 v[18:19], 0
    v_mov_b64 v[20:21], 0
    v_mov_b64 v[22:23], 0
    v_mov_b64 v[24:25], 0
    v_mov_b64 v[26:27], 0
    v_mov_b64 v[28:29], 0
    v_mov_b64 v[30:31], 0
    s_waitcnt lgkmcnt(0)
    v_sub_f32 v48, 0, v14
    v_sub_f32 v49, 0, v14
    v_sub_f32 v50, 0, v14
    v_sub_f32 v51, 0, v14
    v_sub_f32 v52, 0, v14
    v_sub_f32 v53, 0, v14
    v_sub_f32 v54, 0, v14
    v_sub_f32 v55, 0, v14
    v_sub_f32 v56, 0, v14
    v_sub_f32 v57, 0, v14
    v_sub_f32 v58, 0, v14
    v_sub_f32 v59, 0, v14
    v_sub_f32 v60, 0, v14
    v_sub_f32 v61, 0, v14
    v_sub_f32 v62, 0, v14
    v_sub_f32 v63, 0, v14
    s_nop 1
    v_mfma_f32_32x32x16_bf16 v[32:47], v[64:67], v[8:11], v[48:63]
    s_nop 15
    v_exp_f32 v32, v32
    v_exp_f32 v33, v33
    v_exp_f32 v34, v34
    v_exp_f32 v35, v35
    v_exp_f32 v36, v36
    v_exp_f32 v37, v37
    v_exp_f32 v38, v38
    v_exp_f32 v39, v39
    v_exp_f32 v40, v40
    v_exp_f32 v41, v41
    v_exp_f32 v42, v42
    v_exp_f32 v43, v43
    v_exp_f32 v44, v44
    v_exp_f32 v45, v45
    v_exp_f32 v46, v46
    v_exp_f32 v47, v47
    s_nop 1
    v_smfmac_f32_32x32x32_bf16 v[16:31], v[128:131], v[32:39], v5
    v_smfmac_f32_32x32x32_bf16 v[16:31], v[132:135], v[40:47], v5
    v_mfma_f32_32x32x16_bf16 v[32:47], v[68:71], v[8:11], v[48:63]
    s_nop 15
    v_exp_f32 v32, v32
    v_exp_f32 v33, v33
    v_exp_f32 v34, v34
    v_exp_f32 v35, v35
    v_exp_f32 v36, v36
    v_exp_f32 v37, v37
    v_exp_f32 v38, v38
    v_exp_f32 v39, v39
    v_exp_f32 v40, v40
    v_exp_f32 v41, v41
    v_exp_f32 v42, v42
    v_exp_f32 v43, v43
    v_exp_f32 v44, v44
    v_exp_f32 v45, v45
    v_exp_f32 v46, v46
    v_exp_f32 v47, v47
    s_nop 1
    v_smfmac_f32_32x32x32_bf16 v[16:31], v[136:139], v[32:39], v5
    v_smfmac_f32_32x32x32_bf16 v[16:31], v[140:143], v[40:47], v5
    v_mfma_f32_32x32x16_bf16 v[32:47], v[72:75], v[8:11], v[48:63]
    s_nop 15
    v_exp_f32 v32, v32
    v_exp_f32 v33, v33
    v_exp_f32 v34, v34
    v_exp_f32 v35, v35
    v_exp_f32 v36, v36
    v_exp_f32 v37, v37
    v_exp_f32 v38, v38
    v_exp_f32 v39, v39
    v_exp_f32 v40, v40
    v_exp_f32 v41, v41
    v_exp_f32 v42, v42
    v_exp_f32 v43, v43
    v_exp_f32 v44, v44
    v_exp_f32 v45, v45
    v_exp_f32 v46, v46
    v_exp_f32 v47, v47
    s_nop 1
    v_smfmac_f32_32x32x32_bf16 v[16:31], v[144:147], v[32:39], v5
    v_smfmac_f32_32x32x32_bf16 v[16:31], v[148:151], v[40:47], v5
    v_mfma_f32_32x32x16_bf16 v[32:47], v[76:79], v[8:11], v[48:63]
    s_nop 15
    v_exp_f32 v32, v32
    v_exp_f32 v33, v33
    v_exp_f32 v34, v34
    v_exp_f32 v35, v35
    v_exp_f32 v36, v36
    v_exp_f32 v37, v37
    v_exp_f32 v38, v38
    v_exp_f32 v39, v39
    v_exp_f32 v40, v40
    v_exp_f32 v41, v41
    v_exp_f32 v42, v42
    v_exp_f32 v43, v43
    v_exp_f32 v44, v44
    v_exp_f32 v45, v45
    v_exp_f32 v46, v46
    v_exp_f32 v47, v47
    s_nop 1
    v_smfmac_f32_32x32x32_bf16 v[16:31], v[152:155], v[32:39], v5
    v_smfmac_f32_32x32x32_bf16 v[16:31], v[156:159], v[40:47], v5
    v_mfma_f32_32x32x16_bf16 v[32:47], v[80:83], v[8:11], v[48:63]
    s_nop 15
    v_exp_f32 v32, v32
    v_exp_f32 v33, v33
    v_exp_f32 v34, v34
    v_exp_f32 v35, v35
    v_exp_f32 v36, v36
    v_exp_f32 v37, v37
    v_exp_f32 v38, v38
    v_exp_f32 v39, v39
    v_exp_f32 v40, v40
    v_exp_f32 v41, v41
    v_exp_f32 v42, v42
    v_exp_f32 v43, v43
    v_exp_f32 v44, v44
    v_exp_f32 v45, v45
    v_exp_f32 v46, v46
    v_exp_f32 v47, v47
    s_nop 1
    v_smfmac_f32_32x32x32_bf16 v[16:31], v[160:163], v[32:39], v5
    v_smfmac_f32_32x32x32_bf16 v[16:31], v[164:167], v[40:47], v5
    v_mfma_f32_32x32x16_bf16 v[32:47], v[84:87], v[8:11], v[48:63]
    s_nop 15
    v_exp_f32 v32, v32
    v_exp_f32 v33, v33
    v_exp_f32 v34, v34
    v_exp_f32 v35, v35
    v_exp_f32 v36, v36
    v_exp_f32 v37, v37
    v_exp_f32 v38, v38
    v_exp_f32 v39, v39
    v_exp_f32 v40, v40
    v_exp_f32 v41, v41
    v_exp_f32 v42, v42
    v_exp_f32 v43, v43
    v_exp_f32 v44, v44
    v_exp_f32 v45, v45
    v_exp_f32 v46, v46
    v_exp_f32 v47, v47
    s_nop 1
    v_smfmac_f32_32x32x32_bf16 v[16:31], v[168:171], v[32:39], v5
    v_smfmac_f32_32x32x32_bf16 v[16:31], v[172:175], v[40:47], v5
    v_mfma_f32_32x32x16_bf16 v[32:47], v[88:91], v[8:11], v[48:63]
    s_nop 15
    v_exp_f32 v32, v32
    v_exp_f32 v33, v33
    v_exp_f32 v34, v34
    v_exp_f32 v35, v35
    v_exp_f32 v36, v36
    v_exp_f32 v37, v37
    v_exp_f32 v38, v38
    v_exp_f32 v39, v39
    v_exp_f32 v40, v40
    v_exp_f32 v41, v41
    v_exp_f32 v42, v42
    v_exp_f32 v43, v43
    v_exp_f32 v44, v44
    v_exp_f32 v45, v45
    v_exp_f32 v46, v46
    v_exp_f32 v47, v47
    s_nop 1
    v_smfmac_f32_32x32x32_bf16 v[16:31], v[176:179], v[32:39], v5
    v_smfmac_f32_32x32x32_bf16 v[16:31], v[180:183], v[40:47], v5
    v_mfma_f32_32x32x16_bf16 v[32:47], v[92:95], v[8:11], v[48:63]
    s_nop 15
    v_exp_f32 v32, v32
    v_exp_f32 v33, v33
    v_exp_f32 v34, v34
    v_exp_f32 v35, v35
    v_exp_f32 v36, v36
    v_exp_f32 v37, v37
    v_exp_f32 v38, v38
    v_exp_f32 v39, v39
    v_exp_f32 v40, v40
    v_exp_f32 v41, v41
    v_exp_f32 v42, v42
    v_exp_f32 v43, v43
    v_exp_f32 v44, v44
    v_exp_f32 v45, v45
    v_exp_f32 v46, v46
    v_exp_f32 v47, v47
    s_nop 1
    v_smfmac_f32_32x32x32_bf16 v[16:31], v[184:187], v[32:39], v5
    v_smfmac_f32_32x32x32_bf16 v[16:31], v[188:191], v[40:47], v5
    v_mfma_f32_32x32x16_bf16 v[32:47], v[96:99], v[8:11], v[48:63]
    s_nop 15
    v_exp_f32 v32, v32
    v_exp_f32 v33, v33
    v_exp_f32 v34, v34
    v_exp_f32 v35, v35
    v_exp_f32 v36, v36
    v_exp_f32 v37, v37
    v_exp_f32 v38, v38
    v_exp_f32 v39, v39
    v_exp_f32 v40, v40
    v_exp_f32 v41, v41
    v_exp_f32 v42, v42
    v_exp_f32 v43, v43
    v_exp_f32 v44, v44
    v_exp_f32 v45, v45
    v_exp_f32 v46, v46
    v_exp_f32 v47, v47
    s_nop 1
    v_smfmac_f32_32x32x32_bf16 v[16:31], v[192:195], v[32:39], v5
    v_smfmac_f32_32x32x32_bf16 v[16:31], v[196:199], v[40:47], v5
    v_mfma_f32_32x32x16_bf16 v[32:47], v[100:103], v[8:11], v[48:63]
    s_nop 15
    v_exp_f32 v32, v32
    v_exp_f32 v33, v33
    v_exp_f32 v34, v34
    v_exp_f32 v35, v35
    v_exp_f32 v36, v36
    v_exp_f32 v37, v37
    v_exp_f32 v38, v38
    v_exp_f32 v39, v39
    v_exp_f32 v40, v40
    v_exp_f32 v41, v41
    v_exp_f32 v42, v42
    v_exp_f32 v43, v43
    v_exp_f32 v44, v44
    v_exp_f32 v45, v45
    v_exp_f32 v46, v46
    v_exp_f32 v47, v47
    s_nop 1
    v_smfmac_f32_32x32x32_bf16 v[16:31], v[200:203], v[32:39], v5
    v_smfmac_f32_32x32x32_bf16 v[16:31], v[204:207], v[40:47], v5
    v_mfma_f32_32x32x16_bf16 v[32:47], v[104:107], v[8:11], v[48:63]
    s_nop 15
    v_exp_f32 v32, v32
    v_exp_f32 v33, v33
    v_exp_f32 v34, v34
    v_exp_f32 v35, v35
    v_exp_f32 v36, v36
    v_exp_f32 v37, v37
    v_exp_f32 v38, v38
    v_exp_f32 v39, v39
    v_exp_f32 v40, v40
    v_exp_f32 v41, v41
    v_exp_f32 v42, v42
    v_exp_f32 v43, v43
    v_exp_f32 v44, v44
    v_exp_f32 v45, v45
    v_exp_f32 v46, v46
    v_exp_f32 v47, v47
    s_nop 1
    v_smfmac_f32_32x32x32_bf16 v[16:31], v[208:211], v[32:39], v5
    v_smfmac_f32_32x32x32_bf16 v[16:31], v[212:215], v[40:47], v5
    v_mfma_f32_32x32x16_bf16 v[32:47], v[108:111], v[8:11], v[48:63]
    s_nop 15
    v_exp_f32 v32, v32
    v_exp_f32 v33, v33
    v_exp_f32 v34, v34
    v_exp_f32 v35, v35
    v_exp_f32 v36, v36
    v_exp_f32 v37, v37
    v_exp_f32 v38, v38
    v_exp_f32 v39, v39
    v_exp_f32 v40, v40
    v_exp_f32 v41, v41
    v_exp_f32 v42, v42
    v_exp_f32 v43, v43
    v_exp_f32 v44, v44
    v_exp_f32 v45, v45
    v_exp_f32 v46, v46
    v_exp_f32 v47, v47
    s_nop 1
    v_smfmac_f32_32x32x32_bf16 v[16:31], v[216:219], v[32:39], v5
    v_smfmac_f32_32x32x32_bf16 v[16:31], v[220:223], v[40:47], v5
    v_mfma_f32_32x32x16_bf16 v[32:47], v[112:115], v[8:11], v[48:63]
    s_nop 15
    v_exp_f32 v32, v32
    v_exp_f32 v33, v33
    v_exp_f32 v34, v34
    v_exp_f32 v35, v35
    v_exp_f32 v36, v36
    v_exp_f32 v37, v37
    v_exp_f32 v38, v38
    v_exp_f32 v39, v39
    v_exp_f32 v40, v40
    v_exp_f32 v41, v41
    v_exp_f32 v42, v42
    v_exp_f32 v43, v43
    v_exp_f32 v44, v44
    v_exp_f32 v45, v45
    v_exp_f32 v46, v46
    v_exp_f32 v47, v47
    s_nop 1
    v_smfmac_f32_32x32x32_bf16 v[16:31], v[224:227], v[32:39], v5
    v_smfmac_f32_32x32x32_bf16 v[16:31], v[228:231], v[40:47], v5
    v_mfma_f32_32x32x16_bf16 v[32:47], v[116:119], v[8:11], v[48:63]
    s_nop 15
    v_exp_f32 v32, v32
    v_exp_f32 v33, v33
    v_exp_f32 v34, v34
    v_exp_f32 v35, v35
    v_exp_f32 v36, v36
    v_exp_f32 v37, v37
    v_exp_f32 v38, v38
    v_exp_f32 v39, v39
    v_exp_f32 v40, v40
    v_exp_f32 v41, v41
    v_exp_f32 v42, v42
    v_exp_f32 v43, v43
    v_exp_f32 v44, v44
    v_exp_f32 v45, v45
    v_exp_f32 v46, v46
    v_exp_f32 v47, v47
    s_nop 1
    v_smfmac_f32_32x32x32_bf16 v[16:31], v[232:235], v[32:39], v5
    v_smfmac_f32_32x32x32_bf16 v[16:31], v[236:239], v[40:47], v5
    v_mfma_f32_32x32x16_bf16 v[32:47], v[120:123], v[8:11], v[48:63]
    s_nop 15
    v_exp_f32 v32, v32
    v_exp_f32 v33, v33
    v_exp_f32 v34, v34
    v_exp_f32 v35, v35
    v_exp_f32 v36, v36
    v_exp_f32 v37, v37
    v_exp_f32 v38, v38
    v_exp_f32 v39, v39
    v_exp_f32 v40, v40
    v_exp_f32 v41, v41
    v_exp_f32 v42, v42
    v_exp_f32 v43, v43
    v_exp_f32 v44, v44
    v_exp_f32 v45, v45
    v_exp_f32 v46, v46
    v_exp_f32 v47, v47
    s_nop 1
    v_smfmac_f32_32x32x32_bf16 v[16:31], v[240:243], v[32:39], v5
    v_smfmac_f32_32x32x32_bf16 v[16:31], v[244:247], v[40:47], v5
    v_mfma_f32_32x32x16_bf16 v[32:47], v[124:127], v[8:11], v[48:63]
    s_nop 15
    v_exp_f32 v32, v32
    v_exp_f32 v33, v33
    v_exp_f32 v34, v34
    v_exp_f32 v35, v35
    v_exp_f32 v36, v36
    v_exp_f32 v37, v37
    v_exp_f32 v38, v38
    v_exp_f32 v39, v39
    v_exp_f32 v40, v40
    v_exp_f32 v41, v41
    v_exp_f32 v42, v42
    v_exp_f32 v43, v43
    v_exp_f32 v44, v44
    v_exp_f32 v45, v45
    v_exp_f32 v46, v46
    v_exp_f32 v47, v47
    s_nop 1
    v_smfmac_f32_32x32x32_bf16 v[16:31], v[248:251], v[32:39], v5
    v_smfmac_f32_32x32x32_bf16 v[16:31], v[252:255], v[40:47], v5
    s_nop 15
    ds_write_b32 v3, v16 offset:8192
    ds_write_b32 v3, v17 offset:8448
    ds_write_b32 v3, v18 offset:8704
    ds_write_b32 v3, v19 offset:8960
    ds_write_b32 v3, v20 offset:9216
    ds_write_b32 v3, v21 offset:9472
    ds_write_b32 v3, v22 offset:9728
    ds_write_b32 v3, v23 offset:9984
    ds_write_b32 v3, v24 offset:10240
    ds_write_b32 v3, v5 offset:10496
    s_waitcnt lgkmcnt(0)
    v_add_u32 v13, 128, v13
    v_add_u32 v15, 1024, v15
    v_add_u32 v3, 2560, v3
    s_add_u32 s55, s55, 1
    s_cmp_lt_u32 s55, 8
    s_cbranch_scc1 K2_exactloop
    s_branch K2_ctail
K2_end:
.section .rodata,"a"
.p2align 6
.amdhsa_kernel prep_kernel
  .amdhsa_next_free_vgpr 144
  .amdhsa_next_free_sgpr 64
  .amdhsa_accum_offset 144
  .amdhsa_group_segment_fixed_size 0
  .amdhsa_kernarg_size 112
  .amdhsa_user_sgpr_count 2
  .amdhsa_user_sgpr_kernarg_segment_ptr 1
  .amdhsa_system_sgpr_workgroup_id_x 1
.end_amdhsa_kernel
.p2align 6
.amdhsa_kernel attn_kernel
  .amdhsa_next_free_vgpr 256
  .amdhsa_next_free_sgpr 64
  .amdhsa_accum_offset 256
  .amdhsa_group_segment_fixed_size 0
  .amdhsa_kernarg_size 112
  .amdhsa_user_sgpr_count 2
  .amdhsa_user_sgpr_kernarg_segment_ptr 1
  .amdhsa_system_sgpr_workgroup_id_x 1
.end_amdhsa_kernel
```
